```python
import torch

def _softmax(x, axis=-1):
    return torch.softmax(x, dim=axis)
def _gelu(x):
    return torch.nn.functional.gelu(x, approximate="tanh")
def _silu(x):
    return torch.nn.functional.silu(x)
def _sigmoid(x):
    return torch.sigmoid(x)
def _layernorm(x, axis=-1, eps=1e-5):
    m = x.mean(dim=axis, keepdim=True)
    v = x.var(dim=axis, keepdim=True, unbiased=False)
    return (x - m) / torch.sqrt(v + eps)
def _scatter_add(tgt, idx, src, axis=0):
    return tgt.clone().index_add_(axis, idx, src)
def _segment_sum(src, seg, n):
    out = torch.zeros((n,) + src.shape[1:], dtype=src.dtype)
    return out.index_add_(0, seg, src)
def _pad(x, pw):
    flat = tuple(v for pair in reversed(pw) for v in pair)
    return torch.nn.functional.pad(x, flat)

kernel_name = 'concat_heads__gqa_block_cached__mha_block_cached__near_ridge'

def setup_inputs():

    _w = (lambda a: (lambda t: t.to(torch.bfloat16) if t.is_floating_point() else t)(torch.as_tensor(a)))
    def _A_setup():
        B, Sq, D = 32, 48, 512
        Hq, Hkv, Sk, Dh = 32, 8, 512, 128
        assert Hq % Hkv == 0, (Hq, Hkv)
        return {
            "x": _w((lambda *s: torch.randn(*s, dtype=torch.bfloat16) * 0.8)(B, Sq, D)),
            "k_cache": _w((lambda *s: torch.randn(*s, dtype=torch.bfloat16) * 0.8)(B, Hkv, Sk, Dh)),
            "v_cache": _w((lambda *s: torch.randn(*s, dtype=torch.bfloat16) * 0.05)(B, Hkv, Sk, Dh)),
            "wq": _w((lambda *s: torch.randn(*s, dtype=torch.bfloat16) * 0.8)(D, Hq * Dh) * (D ** -0.5)),
            "wo": _w((lambda *s: torch.randn(*s, dtype=torch.bfloat16) * 0.05)(Hq * Dh, D) * ((Hq * Dh) ** -0.5)),
        }
    _A_in = _A_setup()

    def _B_setup():
        B, Sq, D = 32, 48, 512
        H, Sk, Dh = 32, 512, 128
        return {
            "x": _w((lambda *s: torch.randn(*s, dtype=torch.bfloat16) * 0.8)(B, Sq, D)),
            "k_cache": _w((lambda *s: torch.randn(*s, dtype=torch.bfloat16) * 0.8)(B, H, Sk, Dh)),
            "v_cache": _w((lambda *s: torch.randn(*s, dtype=torch.bfloat16) * 0.05)(B, H, Sk, Dh)),
            "wq": _w((lambda *s: torch.randn(*s, dtype=torch.bfloat16) * 0.8)(D, H * Dh) * (D ** -0.5)),
            "wo": _w((lambda *s: torch.randn(*s, dtype=torch.bfloat16) * 0.05)(H * Dh, D) * ((H * Dh) ** -0.5)),
        }
    _B_in = _B_setup()

    return {
        "A_x": _A_in["x"],
        "A_k_cache": _A_in["k_cache"],
        "A_v_cache": _A_in["v_cache"],
        "A_wq": _A_in["wq"],
        "A_wo": _A_in["wo"],
        "B_x": _B_in["x"],
        "B_k_cache": _B_in["k_cache"],
        "B_v_cache": _B_in["v_cache"],
        "B_wq": _B_in["wq"],
        "B_wo": _B_in["wo"],
    }

def reference(A_x, A_k_cache, A_v_cache, A_wq, A_wo, B_x, B_k_cache, B_v_cache, B_wq, B_wo):
    def _A_ref(x, k_cache, v_cache, wq, wo):
        B, Sq, D = x.shape
        Hq, Dh = 32, 128
        Hkv = k_cache.shape[1]
        rep = Hq // Hkv
        q = (lambda x, *d: x.permute(*d))((x @ wq).reshape(B, Sq, Hq, Dh), 0, 2, 1, 3)
        k = (lambda x, n, axis: torch.repeat_interleave(x, n, dim=axis))(k_cache, rep, axis=1)
        v = (lambda x, n, axis: torch.repeat_interleave(x, n, dim=axis))(v_cache, rep, axis=1)
        scores = torch.einsum("bhqd,bhkd->bhqk", q, k) * (Dh ** -0.5)
        p = _softmax(scores, axis=-1)
        o = torch.einsum("bhqk,bhkd->bhqd", p, v)
        return (lambda x, *d: x.permute(*d))(o, 0, 2, 1, 3).reshape(B, Sq, Hq * Dh) @ wo

    def _B_ref(x, k_cache, v_cache, wq, wo):
        B, Sq, D = x.shape
        H, Dh = 32, 128
        q = (lambda x, *d: x.permute(*d))((x @ wq).reshape(B, Sq, H, Dh), 0, 2, 1, 3)
        scores = torch.einsum("bhqd,bhkd->bhqk", q, k_cache) * (Dh ** -0.5)
        p = _softmax(scores, axis=-1)
        o = torch.einsum("bhqk,bhkd->bhqd", p, v_cache)
        return (lambda x, *d: x.permute(*d))(o, 0, 2, 1, 3).reshape(B, Sq, H * Dh) @ wo

    a = _A_ref(A_x, A_k_cache, A_v_cache, A_wq, A_wo)
    b = _B_ref(B_x, B_k_cache, B_v_cache, B_wq, B_wo)
    return torch.concatenate([a, b], axis=-1)
```

```asm
; @launch grid=(256,1,1) block=(512,1,1) lds=151808
.amdgcn_target "amdgcn-amd-amdhsa--gfx950"
.text
.globl concat_heads__gqa_block_cached__mha_block_cached__near_ridge_kernel
.p2align 8
.type concat_heads__gqa_block_cached__mha_block_cached__near_ridge_kernel,@function
concat_heads__gqa_block_cached__mha_block_cached__near_ridge_kernel:
  s_cmp_ge_u32 s2, 256
  s_cbranch_scc1 L_end
  s_load_dwordx16 s[40:55], s[0:1], 0
  s_load_dwordx8 s[56:63], s[0:1], 64
  s_load_dwordx2 s[64:65], s[0:1], 96
  v_lshrrev_b32 v2, 6, v0
  v_and_b32 v1, 63, v0
  v_readfirstlane_b32 s3, v2
  s_and_b32 s6, s2, 7
  s_lshr_b32 s5, s2, 3
  v_and_b32 v3, 15, v1
  v_lshrrev_b32 v2, 4, v1
  s_and_b32 s4, s3, 3
  s_lshr_b32 s7, s3, 2
  v_lshlrev_b32 v4, 1, v2
  v_xor_b32 v3, v3, v4
  v_lshlrev_b32 v3, 4, v3
  v_lshl_add_u32 v8, v2, 8, v3
  v_xor_b32 v9, 0x80, v8
  v_lshlrev_b32 v2, 2, v1
  v_add_u32 v2, 147456, v2
  v_mov_b32 v3, 0
  ds_write_b32 v2, v3
  v_lshrrev_b32 v2, 5, v1
  v_bfe_u32 v3, v1, 3, 2
  v_lshl_add_u32 v3, v2, 3, v3
  v_lshlrev_b32 v3, 13, v3
  v_and_b32 v4, 7, v1
  v_lshrrev_b32 v2, 4, v1
  v_lshlrev_b32 v2, 1, v2
  v_xor_b32 v4, v4, v2
  v_lshl_add_u32 v10, v4, 4, v3
  v_add_u32 v11, 130048, v10
  v_add_u32 v12, 30720, v10
  v_add_u32 v13, 160768, v10
  s_lshl_b32 s73, s4, 14
  s_add_u32 s73, s73, 90112
  s_lshl_b32 s74, s4, 13
  s_cmp_eq_u32 s7, 0
  s_cselect_b32 s73, s73, s74
  s_lshl_b32 s69, s6, 2
  s_add_u32 s69, s69, s4
  s_lshl_b32 s83, s5, 5
  s_add_u32 s83, s83, s69
  s_lshl_b32 s83, s83, 17
  s_lshl_b32 s69, s69, 8
  s_lshl_b32 s74, s7, 7
  s_add_u32 s69, s69, s74
  s_and_b32 s70, s5, 15
  s_mov_b32 s71, s70
  s_waitcnt lgkmcnt(0)
  s_getpc_b64 s[10:11]
L_pcref:
  s_lshl_b32 s74, s5, 3
  s_add_u32 s74, s74, s3
  s_mul_i32 s74, s74, 192
  s_min_u32 s74, s74, L_code_end-L_pcref-192
  s_load_dword s100, s[10:11], s74
  s_add_u32 s74, s74, 64
  s_load_dword s101, s[10:11], s74
  s_add_u32 s74, s74, 64
  s_load_dword s100, s[10:11], s74
  s_mov_b32 s24, s56
  s_mov_b32 s25, s57
  s_mov_b32 s26, 4194304
  s_mov_b32 s27, 0x20000
  s_mul_i32 s77, s70, 262144
  s_add_u32 s77, s77, s69
  s_mov_b32 m0, s73
  s_nop 0
  buffer_load_dwordx4 v10, s[24:27], s77 offen lds
  buffer_load_dwordx4 v11, s[24:27], s77 offen offset:1024 lds
  buffer_load_dwordx4 v12, s[24:27], s77 offen offset:2048 lds
  buffer_load_dwordx4 v13, s[24:27], s77 offen offset:3072 lds
  s_add_u32 s70, s70, 1
  s_and_b32 s70, s70, 15
  s_mov_b32 s12, s50
  s_mov_b32 s13, s51
  s_mov_b32 s14, 1572864
  s_mov_b32 s15, 0x20000
  v_lshrrev_b32 v2, 4, v1
  v_and_b32 v4, 7, v1
  v_xor_b32 v4, v4, v2
  v_lshrrev_b32 v36, 3, v1
  v_lshlrev_b32 v36, 10, v36
  v_lshl_add_u32 v36, v4, 4, v36
  s_mul_i32 s74, s5, 49152
  s_mul_i32 s75, s3, 128
  s_add_u32 s74, s74, s75
  s_mul_i32 s75, s3, 6144
  s_add_u32 s75, s75, 32768
  v_xor_b32 v5, 64, v36
  s_add_u32 m0, s75, 0
  s_add_u32 s77, s74, 0
  buffer_load_dwordx4 v36, s[12:15], s77 offen lds
  s_add_u32 m0, s75, 1024
  s_add_u32 s77, s74, 8192
  buffer_load_dwordx4 v5, s[12:15], s77 offen lds
  s_add_u32 m0, s75, 2048
  s_add_u32 s77, s74, 16384
  buffer_load_dwordx4 v36, s[12:15], s77 offen lds
  s_add_u32 m0, s75, 3072
  s_add_u32 s77, s74, 24576
  buffer_load_dwordx4 v5, s[12:15], s77 offen lds
  s_add_u32 m0, s75, 4096
  s_add_u32 s77, s74, 32768
  buffer_load_dwordx4 v36, s[12:15], s77 offen lds
  s_add_u32 m0, s75, 5120
  s_add_u32 s77, s74, 40960
  buffer_load_dwordx4 v5, s[12:15], s77 offen lds
  v_mov_b32 v24, 147456
  v_mov_b32 v25, 1
  s_lshl_b32 s74, s4, 2
  v_add_u32 v0, s74, v24
  v_lshrrev_b32 v2, 2, v1
  v_and_b32 v3, 3, v1
  v_bfe_u32 v4, v1, 3, 2
  v_lshlrev_b32 v3, 3, v3
  v_lshl_add_u32 v3, v4, 5, v3
  v_lshl_add_u32 v3, v2, 7, v3
  v_add_u32 v18, s73, v3
  v_xor_b32 v4, 32, v3
  v_add_u32 v19, s73, v4
  v_xor_b32 v4, 64, v3
  v_add_u32 v20, s73, v4
  v_xor_b32 v4, 96, v3
  v_add_u32 v21, s73, v4
  v_and_b32 v2, 15, v1
  v_bfe_u32 v3, v1, 4, 1
  v_lshrrev_b32 v5, 5, v1
  v_lshl_add_u32 v3, v3, 1, v5
  v_and_b32 v4, 7, v2
  v_lshlrev_b32 v4, 1, v4
  v_xor_b32 v4, v4, v3
  v_lshlrev_b32 v4, 4, v4
  v_lshl_add_u32 v14, v2, 8, v4
  v_xor_b32 v15, 64, v14
  v_xor_b32 v16, 128, v14
  v_xor_b32 v17, 192, v14
  v_bfe_u32 v2, v1, 3, 1
  v_lshlrev_b32 v2, 10, v2
  v_and_b32 v3, 7, v1
  v_lshl_add_u32 v2, v3, 7, v2
  v_bfe_u32 v3, v1, 1, 3
  v_lshrrev_b32 v4, 4, v1
  v_xor_b32 v3, v3, v4
  v_lshl_add_u32 v2, v3, 4, v2
  v_add_u32 v23, 32768, v2
  s_mov_b32 s66, 0x3e0293ee
  s_mov_b32 s78, 0x41000000
  s_mov_b32 s28, s64
  s_mov_b32 s29, s65
  s_mov_b32 s30, 536870912
  s_mov_b32 s31, 0x20000
  s_mov_b32 s32, s60
  s_mov_b32 s33, s61
  s_mov_b32 s34, 3145728
  s_mov_b32 s35, 0x20000
  s_mov_b32 s36, s62
  s_mov_b32 s37, s63
  s_mov_b32 s38, 256
  s_mov_b32 s39, 0x20000
  s_cmp_ge_u32 s3, 4
  s_cbranch_scc1 L_teamA
  s_mov_b32 s16, s52
  s_mov_b32 s17, s53
  s_mov_b32 s18, 134217728
  s_mov_b32 s19, 0x20000
  s_mov_b32 s20, s54
  s_mov_b32 s21, s55
  s_mov_b32 s22, 134217728
  s_mov_b32 s23, 0x20000
  s_lshr_b32 s81, s83, 17
  s_add_u32 s81, s81, s5
  s_and_b32 s81, s81, 15
  s_sub_u32 s76, s73, 8192
  s_getreg_b32 s79, hwreg(HW_REG_XCC_ID)
  s_and_b32 s79, s79, 1
  s_xor_b32 s79, s79, 1
  v_add_u32 v14, s76, v14
  v_add_u32 v15, s76, v15
  v_add_u32 v16, s76, v16
  v_add_u32 v17, s76, v17
  s_waitcnt vmcnt(0)
  s_mul_i32 s77, s70, 262144
  s_add_u32 s77, s77, s69
  s_add_u32 m0, s73, 4096
  s_nop 0
  buffer_load_dwordx4 v10, s[24:27], s77 offen lds
  buffer_load_dwordx4 v11, s[24:27], s77 offen offset:1024 lds
  buffer_load_dwordx4 v12, s[24:27], s77 offen offset:2048 lds
  buffer_load_dwordx4 v13, s[24:27], s77 offen offset:3072 lds
  s_add_u32 s70, s70, 1
  s_and_b32 s70, s70, 15
  s_barrier
  v_mov_b32 v40, 0
  v_mov_b32 v41, 0
  v_mov_b32 v42, 0
  v_mov_b32 v43, 0
  v_mov_b32 v44, 0
  v_mov_b32 v45, 0
  v_mov_b32 v46, 0
  v_mov_b32 v47, 0
  v_mov_b32 v48, 0
  v_mov_b32 v49, 0
  v_mov_b32 v50, 0
  v_mov_b32 v51, 0
  v_mov_b32 v52, 0
  v_mov_b32 v53, 0
  v_mov_b32 v54, 0
  v_mov_b32 v55, 0
  v_mov_b32 v56, 0
  v_mov_b32 v57, 0
  v_mov_b32 v58, 0
  v_mov_b32 v59, 0
  v_mov_b32 v60, 0
  v_mov_b32 v61, 0
  v_mov_b32 v62, 0
  v_mov_b32 v63, 0
  v_mov_b32 v64, 0
  v_mov_b32 v65, 0
  v_mov_b32 v66, 0
  v_mov_b32 v67, 0
  v_mov_b32 v68, 0
  v_mov_b32 v69, 0
  v_mov_b32 v70, 0
  v_mov_b32 v71, 0
  v_mov_b32 v72, 0
  v_mov_b32 v73, 0
  v_mov_b32 v74, 0
  v_mov_b32 v75, 0
  v_mov_b32 v76, 0
  v_mov_b32 v77, 0
  v_mov_b32 v78, 0
  v_mov_b32 v79, 0
  v_mov_b32 v80, 0
  v_mov_b32 v81, 0
  v_mov_b32 v82, 0
  v_mov_b32 v83, 0
  v_mov_b32 v84, 0
  v_mov_b32 v85, 0
  v_mov_b32 v86, 0
  v_mov_b32 v87, 0
  s_and_b32 s74, s71, 1
  s_lshl_b32 s74, s74, 6
  s_lshr_b32 s75, s71, 1
  v_xor_b32 v22, s74, v23
  s_mul_i32 s75, s75, 6144
  v_add_u32 v22, s75, v22
  s_add_u32 s71, s71, 1
  s_and_b32 s71, s71, 15
  s_waitcnt vmcnt(4)
  ds_read_b64_tr_b16 v[136:137], v18 offset:0
  ds_read_b64_tr_b16 v[140:141], v19 offset:0
  ds_read_b64_tr_b16 v[144:145], v20 offset:0
  ds_read_b64_tr_b16 v[148:149], v21 offset:0
  ds_read_b64_tr_b16 v[138:139], v18 offset:2048
  ds_read_b64_tr_b16 v[142:143], v19 offset:2048
  ds_read_b64_tr_b16 v[146:147], v20 offset:2048
  ds_read_b64_tr_b16 v[150:151], v21 offset:2048
  ds_read_b128 v[200:203], v22 offset:0
  ds_read_b128 v[204:207], v22 offset:2048
  ds_read_b128 v[208:211], v22 offset:4096
  s_waitcnt lgkmcnt(0)
  s_mul_i32 s77, s70, 262144
  s_add_u32 s77, s77, s69
  s_mov_b32 m0, s73
  s_nop 0
  buffer_load_dwordx4 v10, s[24:27], s77 offen lds
  buffer_load_dwordx4 v11, s[24:27], s77 offen offset:1024 lds
  buffer_load_dwordx4 v12, s[24:27], s77 offen offset:2048 lds
  buffer_load_dwordx4 v13, s[24:27], s77 offen offset:3072 lds
  s_add_u32 s70, s70, 1
  s_and_b32 s70, s70, 15
  s_and_b32 s74, s71, 1
  s_lshl_b32 s74, s74, 6
  s_lshr_b32 s75, s71, 1
  v_xor_b32 v22, s74, v23
  s_mul_i32 s75, s75, 6144
  v_add_u32 v22, s75, v22
  s_add_u32 s71, s71, 1
  s_and_b32 s71, s71, 15
  s_waitcnt vmcnt(4)
  ds_read_b64_tr_b16 v[168:169], v18 offset:4096
  ds_read_b64_tr_b16 v[172:173], v19 offset:4096
  ds_read_b64_tr_b16 v[176:177], v20 offset:4096
  ds_read_b64_tr_b16 v[180:181], v21 offset:4096
  ds_read_b64_tr_b16 v[170:171], v18 offset:6144
  ds_read_b64_tr_b16 v[174:175], v19 offset:6144
  ds_read_b64_tr_b16 v[178:179], v20 offset:6144
  ds_read_b64_tr_b16 v[182:183], v21 offset:6144
  ds_read_b128 v[212:215], v22 offset:0
  ds_read_b128 v[216:219], v22 offset:2048
  ds_read_b128 v[220:223], v22 offset:4096
  v_mfma_f32_16x16x32_bf16 v[40:43], v[136:139], v[200:203], v[40:43]
  v_mfma_f32_16x16x32_bf16 v[44:47], v[136:139], v[204:207], v[44:47]
  v_mfma_f32_16x16x32_bf16 v[48:51], v[136:139], v[208:211], v[48:51]
  v_mfma_f32_16x16x32_bf16 v[52:55], v[140:143], v[200:203], v[52:55]
  v_mfma_f32_16x16x32_bf16 v[56:59], v[140:143], v[204:207], v[56:59]
  v_mfma_f32_16x16x32_bf16 v[60:63], v[140:143], v[208:211], v[60:63]
  s_waitcnt lgkmcnt(0)
  s_mul_i32 s77, s70, 262144
  s_add_u32 s77, s77, s69
  s_add_u32 m0, s73, 4096
  s_nop 0
  buffer_load_dwordx4 v10, s[24:27], s77 offen lds
  buffer_load_dwordx4 v11, s[24:27], s77 offen offset:1024 lds
  buffer_load_dwordx4 v12, s[24:27], s77 offen offset:2048 lds
  buffer_load_dwordx4 v13, s[24:27], s77 offen offset:3072 lds
  s_add_u32 s70, s70, 1
  s_and_b32 s70, s70, 15
  v_mfma_f32_16x16x32_bf16 v[64:67], v[144:147], v[200:203], v[64:67]
  v_mfma_f32_16x16x32_bf16 v[68:71], v[144:147], v[204:207], v[68:71]
  v_mfma_f32_16x16x32_bf16 v[72:75], v[144:147], v[208:211], v[72:75]
  v_mfma_f32_16x16x32_bf16 v[76:79], v[148:151], v[200:203], v[76:79]
  v_mfma_f32_16x16x32_bf16 v[80:83], v[148:151], v[204:207], v[80:83]
  v_mfma_f32_16x16x32_bf16 v[84:87], v[148:151], v[208:211], v[84:87]
  s_mov_b32 s72, 5
L_qb_1:
  s_and_b32 s74, s71, 1
  s_lshl_b32 s74, s74, 6
  s_lshr_b32 s75, s71, 1
  v_xor_b32 v22, s74, v23
  s_mul_i32 s75, s75, 6144
  v_add_u32 v22, s75, v22
  s_add_u32 s71, s71, 1
  s_and_b32 s71, s71, 15
  s_waitcnt vmcnt(4)
  ds_read_b64_tr_b16 v[136:137], v18 offset:0
  ds_read_b64_tr_b16 v[140:141], v19 offset:0
  ds_read_b64_tr_b16 v[144:145], v20 offset:0
  ds_read_b64_tr_b16 v[148:149], v21 offset:0
  ds_read_b64_tr_b16 v[138:139], v18 offset:2048
  ds_read_b64_tr_b16 v[142:143], v19 offset:2048
  ds_read_b64_tr_b16 v[146:147], v20 offset:2048
  ds_read_b64_tr_b16 v[150:151], v21 offset:2048
  ds_read_b128 v[200:203], v22 offset:0
  ds_read_b128 v[204:207], v22 offset:2048
  ds_read_b128 v[208:211], v22 offset:4096
  v_mfma_f32_16x16x32_bf16 v[40:43], v[168:171], v[212:215], v[40:43]
  v_mfma_f32_16x16x32_bf16 v[44:47], v[168:171], v[216:219], v[44:47]
  v_mfma_f32_16x16x32_bf16 v[48:51], v[168:171], v[220:223], v[48:51]
  v_mfma_f32_16x16x32_bf16 v[52:55], v[172:175], v[212:215], v[52:55]
  v_mfma_f32_16x16x32_bf16 v[56:59], v[172:175], v[216:219], v[56:59]
  v_mfma_f32_16x16x32_bf16 v[60:63], v[172:175], v[220:223], v[60:63]
  s_waitcnt lgkmcnt(0)
  s_mul_i32 s77, s70, 262144
  s_add_u32 s77, s77, s69
  s_mov_b32 m0, s73
  s_nop 0
  buffer_load_dwordx4 v10, s[24:27], s77 offen lds
  buffer_load_dwordx4 v11, s[24:27], s77 offen offset:1024 lds
  buffer_load_dwordx4 v12, s[24:27], s77 offen offset:2048 lds
  buffer_load_dwordx4 v13, s[24:27], s77 offen offset:3072 lds
  s_add_u32 s70, s70, 1
  s_and_b32 s70, s70, 15
  v_mfma_f32_16x16x32_bf16 v[64:67], v[176:179], v[212:215], v[64:67]
  v_mfma_f32_16x16x32_bf16 v[68:71], v[176:179], v[216:219], v[68:71]
  v_mfma_f32_16x16x32_bf16 v[72:75], v[176:179], v[220:223], v[72:75]
  v_mfma_f32_16x16x32_bf16 v[76:79], v[180:183], v[212:215], v[76:79]
  v_mfma_f32_16x16x32_bf16 v[80:83], v[180:183], v[216:219], v[80:83]
  v_mfma_f32_16x16x32_bf16 v[84:87], v[180:183], v[220:223], v[84:87]
  s_and_b32 s74, s71, 1
  s_lshl_b32 s74, s74, 6
  s_lshr_b32 s75, s71, 1
  v_xor_b32 v22, s74, v23
  s_mul_i32 s75, s75, 6144
  v_add_u32 v22, s75, v22
  s_add_u32 s71, s71, 1
  s_and_b32 s71, s71, 15
  s_waitcnt vmcnt(4)
  ds_read_b64_tr_b16 v[168:169], v18 offset:4096
  ds_read_b64_tr_b16 v[172:173], v19 offset:4096
  ds_read_b64_tr_b16 v[176:177], v20 offset:4096
  ds_read_b64_tr_b16 v[180:181], v21 offset:4096
  ds_read_b64_tr_b16 v[170:171], v18 offset:6144
  ds_read_b64_tr_b16 v[174:175], v19 offset:6144
  ds_read_b64_tr_b16 v[178:179], v20 offset:6144
  ds_read_b64_tr_b16 v[182:183], v21 offset:6144
  ds_read_b128 v[212:215], v22 offset:0
  ds_read_b128 v[216:219], v22 offset:2048
  ds_read_b128 v[220:223], v22 offset:4096
  v_mfma_f32_16x16x32_bf16 v[40:43], v[136:139], v[200:203], v[40:43]
  v_mfma_f32_16x16x32_bf16 v[44:47], v[136:139], v[204:207], v[44:47]
  v_mfma_f32_16x16x32_bf16 v[48:51], v[136:139], v[208:211], v[48:51]
  v_mfma_f32_16x16x32_bf16 v[52:55], v[140:143], v[200:203], v[52:55]
  v_mfma_f32_16x16x32_bf16 v[56:59], v[140:143], v[204:207], v[56:59]
  v_mfma_f32_16x16x32_bf16 v[60:63], v[140:143], v[208:211], v[60:63]
  s_waitcnt lgkmcnt(0)
  s_mul_i32 s77, s70, 262144
  s_add_u32 s77, s77, s69
  s_add_u32 m0, s73, 4096
  s_nop 0
  buffer_load_dwordx4 v10, s[24:27], s77 offen lds
  buffer_load_dwordx4 v11, s[24:27], s77 offen offset:1024 lds
  buffer_load_dwordx4 v12, s[24:27], s77 offen offset:2048 lds
  buffer_load_dwordx4 v13, s[24:27], s77 offen offset:3072 lds
  s_add_u32 s70, s70, 1
  s_and_b32 s70, s70, 15
  v_mfma_f32_16x16x32_bf16 v[64:67], v[144:147], v[200:203], v[64:67]
  v_mfma_f32_16x16x32_bf16 v[68:71], v[144:147], v[204:207], v[68:71]
  v_mfma_f32_16x16x32_bf16 v[72:75], v[144:147], v[208:211], v[72:75]
  v_mfma_f32_16x16x32_bf16 v[76:79], v[148:151], v[200:203], v[76:79]
  v_mfma_f32_16x16x32_bf16 v[80:83], v[148:151], v[204:207], v[80:83]
  v_mfma_f32_16x16x32_bf16 v[84:87], v[148:151], v[208:211], v[84:87]
  s_sub_u32 s72, s72, 1
  s_cmp_lg_u32 s72, 0
  s_cbranch_scc1 L_qb_1
  s_and_b32 s74, s71, 1
  s_lshl_b32 s74, s74, 6
  s_lshr_b32 s75, s71, 1
  v_xor_b32 v22, s74, v23
  s_mul_i32 s75, s75, 6144
  v_add_u32 v22, s75, v22
  s_add_u32 s71, s71, 1
  s_and_b32 s71, s71, 15
  s_waitcnt vmcnt(4)
  ds_read_b64_tr_b16 v[136:137], v18 offset:0
  ds_read_b64_tr_b16 v[140:141], v19 offset:0
  ds_read_b64_tr_b16 v[144:145], v20 offset:0
  ds_read_b64_tr_b16 v[148:149], v21 offset:0
  ds_read_b64_tr_b16 v[138:139], v18 offset:2048
  ds_read_b64_tr_b16 v[142:143], v19 offset:2048
  ds_read_b64_tr_b16 v[146:147], v20 offset:2048
  ds_read_b64_tr_b16 v[150:151], v21 offset:2048
  ds_read_b128 v[200:203], v22 offset:0
  ds_read_b128 v[204:207], v22 offset:2048
  ds_read_b128 v[208:211], v22 offset:4096
  v_mfma_f32_16x16x32_bf16 v[40:43], v[168:171], v[212:215], v[40:43]
  v_mfma_f32_16x16x32_bf16 v[44:47], v[168:171], v[216:219], v[44:47]
  v_mfma_f32_16x16x32_bf16 v[48:51], v[168:171], v[220:223], v[48:51]
  v_mfma_f32_16x16x32_bf16 v[52:55], v[172:175], v[212:215], v[52:55]
  v_mfma_f32_16x16x32_bf16 v[56:59], v[172:175], v[216:219], v[56:59]
  v_mfma_f32_16x16x32_bf16 v[60:63], v[172:175], v[220:223], v[60:63]
  s_waitcnt lgkmcnt(0)
  s_mul_i32 s77, s70, 262144
  s_add_u32 s77, s77, s69
  s_mov_b32 m0, s73
  s_nop 0
  buffer_load_dwordx4 v10, s[24:27], s77 offen lds
  buffer_load_dwordx4 v11, s[24:27], s77 offen offset:1024 lds
  buffer_load_dwordx4 v12, s[24:27], s77 offen offset:2048 lds
  buffer_load_dwordx4 v13, s[24:27], s77 offen offset:3072 lds
  s_add_u32 s70, s70, 1
  s_and_b32 s70, s70, 15
  v_mfma_f32_16x16x32_bf16 v[64:67], v[176:179], v[212:215], v[64:67]
  v_mfma_f32_16x16x32_bf16 v[68:71], v[176:179], v[216:219], v[68:71]
  v_mfma_f32_16x16x32_bf16 v[72:75], v[176:179], v[220:223], v[72:75]
  v_mfma_f32_16x16x32_bf16 v[76:79], v[180:183], v[212:215], v[76:79]
  v_mfma_f32_16x16x32_bf16 v[80:83], v[180:183], v[216:219], v[80:83]
  v_mfma_f32_16x16x32_bf16 v[84:87], v[180:183], v[220:223], v[84:87]
  s_and_b32 s74, s71, 1
  s_lshl_b32 s74, s74, 6
  s_lshr_b32 s75, s71, 1
  v_xor_b32 v22, s74, v23
  s_mul_i32 s75, s75, 6144
  v_add_u32 v22, s75, v22
  s_add_u32 s71, s71, 1
  s_and_b32 s71, s71, 15
  s_waitcnt vmcnt(4)
  ds_read_b64_tr_b16 v[168:169], v18 offset:4096
  ds_read_b64_tr_b16 v[172:173], v19 offset:4096
  ds_read_b64_tr_b16 v[176:177], v20 offset:4096
  ds_read_b64_tr_b16 v[180:181], v21 offset:4096
  ds_read_b64_tr_b16 v[170:171], v18 offset:6144
  ds_read_b64_tr_b16 v[174:175], v19 offset:6144
  ds_read_b64_tr_b16 v[178:179], v20 offset:6144
  ds_read_b64_tr_b16 v[182:183], v21 offset:6144
  ds_read_b128 v[212:215], v22 offset:0
  ds_read_b128 v[216:219], v22 offset:2048
  ds_read_b128 v[220:223], v22 offset:4096
  v_mfma_f32_16x16x32_bf16 v[40:43], v[136:139], v[200:203], v[40:43]
  v_mfma_f32_16x16x32_bf16 v[44:47], v[136:139], v[204:207], v[44:47]
  v_mfma_f32_16x16x32_bf16 v[48:51], v[136:139], v[208:211], v[48:51]
  v_mfma_f32_16x16x32_bf16 v[52:55], v[140:143], v[200:203], v[52:55]
  v_mfma_f32_16x16x32_bf16 v[56:59], v[140:143], v[204:207], v[56:59]
  v_mfma_f32_16x16x32_bf16 v[60:63], v[140:143], v[208:211], v[60:63]
  s_waitcnt lgkmcnt(0)
  s_mul_i32 s77, s70, 262144
  s_add_u32 s77, s77, s69
  s_add_u32 m0, s73, 4096
  s_nop 0
  buffer_load_dwordx4 v10, s[24:27], s77 offen lds
  buffer_load_dwordx4 v11, s[24:27], s77 offen offset:1024 lds
  buffer_load_dwordx4 v12, s[24:27], s77 offen offset:2048 lds
  buffer_load_dwordx4 v13, s[24:27], s77 offen offset:3072 lds
  s_add_u32 s70, s70, 1
  s_and_b32 s70, s70, 15
  s_lshl_b32 s67, s81, 13
  s_add_u32 s67, s67, s83
  s_mov_b32 s68, s67
  s_mov_b32 m0, s76
  s_nop 0
  buffer_load_dwordx4 v8, s[16:19], s67 offen nt lds
  buffer_load_dwordx4 v9, s[16:19], s67 offen offset:1024 nt lds
  buffer_load_dwordx4 v8, s[16:19], s67 offen offset:2048 nt lds
  buffer_load_dwordx4 v9, s[16:19], s67 offen offset:3072 nt lds
  s_add_u32 s67, s67, 4096
  s_add_u32 m0, s76, 4096
  s_nop 0
  buffer_load_dwordx4 v8, s[16:19], s67 offen nt lds
  buffer_load_dwordx4 v9, s[16:19], s67 offen offset:1024 nt lds
  buffer_load_dwordx4 v8, s[16:19], s67 offen offset:2048 nt lds
  buffer_load_dwordx4 v9, s[16:19], s67 offen offset:3072 nt lds
  s_add_u32 s81, s81, 1
  s_and_b32 s81, s81, 15
  v_mfma_f32_16x16x32_bf16 v[64:67], v[144:147], v[200:203], v[64:67]
  v_mfma_f32_16x16x32_bf16 v[68:71], v[144:147], v[204:207], v[68:71]
  v_mfma_f32_16x16x32_bf16 v[72:75], v[144:147], v[208:211], v[72:75]
  v_mfma_f32_16x16x32_bf16 v[76:79], v[148:151], v[200:203], v[76:79]
  v_mfma_f32_16x16x32_bf16 v[80:83], v[148:151], v[204:207], v[80:83]
  v_mfma_f32_16x16x32_bf16 v[84:87], v[148:151], v[208:211], v[84:87]
  s_and_b32 s74, s71, 1
  s_lshl_b32 s74, s74, 6
  s_lshr_b32 s75, s71, 1
  v_xor_b32 v22, s74, v23
  s_mul_i32 s75, s75, 6144
  v_add_u32 v22, s75, v22
  s_add_u32 s71, s71, 1
  s_and_b32 s71, s71, 15
  s_waitcnt vmcnt(12)
  ds_read_b64_tr_b16 v[136:137], v18 offset:0
  ds_read_b64_tr_b16 v[140:141], v19 offset:0
  ds_read_b64_tr_b16 v[144:145], v20 offset:0
  ds_read_b64_tr_b16 v[148:149], v21 offset:0
  ds_read_b64_tr_b16 v[138:139], v18 offset:2048
  ds_read_b64_tr_b16 v[142:143], v19 offset:2048
  ds_read_b64_tr_b16 v[146:147], v20 offset:2048
  ds_read_b64_tr_b16 v[150:151], v21 offset:2048
  ds_read_b128 v[200:203], v22 offset:0
  ds_read_b128 v[204:207], v22 offset:2048
  ds_read_b128 v[208:211], v22 offset:4096
  v_mfma_f32_16x16x32_bf16 v[40:43], v[168:171], v[212:215], v[40:43]
  v_mfma_f32_16x16x32_bf16 v[44:47], v[168:171], v[216:219], v[44:47]
  v_mfma_f32_16x16x32_bf16 v[48:51], v[168:171], v[220:223], v[48:51]
  v_mfma_f32_16x16x32_bf16 v[52:55], v[172:175], v[212:215], v[52:55]
  v_mfma_f32_16x16x32_bf16 v[56:59], v[172:175], v[216:219], v[56:59]
  v_mfma_f32_16x16x32_bf16 v[60:63], v[172:175], v[220:223], v[60:63]
  s_waitcnt lgkmcnt(0)
  v_mfma_f32_16x16x32_bf16 v[64:67], v[176:179], v[212:215], v[64:67]
  v_mfma_f32_16x16x32_bf16 v[68:71], v[176:179], v[216:219], v[68:71]
  v_mfma_f32_16x16x32_bf16 v[72:75], v[176:179], v[220:223], v[72:75]
  v_mfma_f32_16x16x32_bf16 v[76:79], v[180:183], v[212:215], v[76:79]
  v_mfma_f32_16x16x32_bf16 v[80:83], v[180:183], v[216:219], v[80:83]
  v_mfma_f32_16x16x32_bf16 v[84:87], v[180:183], v[220:223], v[84:87]
  s_and_b32 s74, s71, 1
  s_lshl_b32 s74, s74, 6
  s_lshr_b32 s75, s71, 1
  v_xor_b32 v22, s74, v23
  s_mul_i32 s75, s75, 6144
  v_add_u32 v22, s75, v22
  s_add_u32 s71, s71, 1
  s_and_b32 s71, s71, 15
  s_waitcnt vmcnt(8)
  ds_read_b64_tr_b16 v[168:169], v18 offset:4096
  ds_read_b64_tr_b16 v[172:173], v19 offset:4096
  ds_read_b64_tr_b16 v[176:177], v20 offset:4096
  ds_read_b64_tr_b16 v[180:181], v21 offset:4096
  ds_read_b64_tr_b16 v[170:171], v18 offset:6144
  ds_read_b64_tr_b16 v[174:175], v19 offset:6144
  ds_read_b64_tr_b16 v[178:179], v20 offset:6144
  ds_read_b64_tr_b16 v[182:183], v21 offset:6144
  ds_read_b128 v[212:215], v22 offset:0
  ds_read_b128 v[216:219], v22 offset:2048
  ds_read_b128 v[220:223], v22 offset:4096
  v_mfma_f32_16x16x32_bf16 v[40:43], v[136:139], v[200:203], v[40:43]
  v_mfma_f32_16x16x32_bf16 v[44:47], v[136:139], v[204:207], v[44:47]
  v_mfma_f32_16x16x32_bf16 v[48:51], v[136:139], v[208:211], v[48:51]
  v_mfma_f32_16x16x32_bf16 v[52:55], v[140:143], v[200:203], v[52:55]
  v_mfma_f32_16x16x32_bf16 v[56:59], v[140:143], v[204:207], v[56:59]
  v_mfma_f32_16x16x32_bf16 v[60:63], v[140:143], v[208:211], v[60:63]
  s_waitcnt lgkmcnt(0)
  s_add_u32 m0, s76, 8192
  s_nop 0
  buffer_load_dwordx4 v8, s[20:23], s68 offen nt lds
  buffer_load_dwordx4 v9, s[20:23], s68 offen offset:1024 nt lds
  buffer_load_dwordx4 v8, s[20:23], s68 offen offset:2048 nt lds
  buffer_load_dwordx4 v9, s[20:23], s68 offen offset:3072 nt lds
  s_add_u32 s68, s68, 4096
  s_add_u32 m0, s76, 12288
  s_nop 0
  buffer_load_dwordx4 v8, s[20:23], s68 offen nt lds
  buffer_load_dwordx4 v9, s[20:23], s68 offen offset:1024 nt lds
  buffer_load_dwordx4 v8, s[20:23], s68 offen offset:2048 nt lds
  buffer_load_dwordx4 v9, s[20:23], s68 offen offset:3072 nt lds
  v_mfma_f32_16x16x32_bf16 v[64:67], v[144:147], v[200:203], v[64:67]
  v_mfma_f32_16x16x32_bf16 v[68:71], v[144:147], v[204:207], v[68:71]
  v_mfma_f32_16x16x32_bf16 v[72:75], v[144:147], v[208:211], v[72:75]
  v_mfma_f32_16x16x32_bf16 v[76:79], v[148:151], v[200:203], v[76:79]
  v_mfma_f32_16x16x32_bf16 v[80:83], v[148:151], v[204:207], v[80:83]
  v_mfma_f32_16x16x32_bf16 v[84:87], v[148:151], v[208:211], v[84:87]
  v_mfma_f32_16x16x32_bf16 v[40:43], v[168:171], v[212:215], v[40:43]
  v_mfma_f32_16x16x32_bf16 v[44:47], v[168:171], v[216:219], v[44:47]
  v_mfma_f32_16x16x32_bf16 v[48:51], v[168:171], v[220:223], v[48:51]
  v_mfma_f32_16x16x32_bf16 v[52:55], v[172:175], v[212:215], v[52:55]
  v_mfma_f32_16x16x32_bf16 v[56:59], v[172:175], v[216:219], v[56:59]
  v_mfma_f32_16x16x32_bf16 v[60:63], v[172:175], v[220:223], v[60:63]
  v_mfma_f32_16x16x32_bf16 v[64:67], v[176:179], v[212:215], v[64:67]
  v_mfma_f32_16x16x32_bf16 v[68:71], v[176:179], v[216:219], v[68:71]
  v_mfma_f32_16x16x32_bf16 v[72:75], v[176:179], v[220:223], v[72:75]
  v_mfma_f32_16x16x32_bf16 v[76:79], v[180:183], v[212:215], v[76:79]
  v_mfma_f32_16x16x32_bf16 v[80:83], v[180:183], v[216:219], v[80:83]
  v_mfma_f32_16x16x32_bf16 v[84:87], v[180:183], v[220:223], v[84:87]
  s_nop 7
  v_cvt_pk_bf16_f32 v136, v40, v41
  v_cvt_pk_bf16_f32 v137, v42, v43
  v_cvt_pk_bf16_f32 v138, v52, v53
  v_cvt_pk_bf16_f32 v139, v54, v55
  v_cvt_pk_bf16_f32 v140, v44, v45
  v_cvt_pk_bf16_f32 v141, v46, v47
  v_cvt_pk_bf16_f32 v142, v56, v57
  v_cvt_pk_bf16_f32 v143, v58, v59
  v_cvt_pk_bf16_f32 v144, v48, v49
  v_cvt_pk_bf16_f32 v145, v50, v51
  v_cvt_pk_bf16_f32 v146, v60, v61
  v_cvt_pk_bf16_f32 v147, v62, v63
  v_cvt_pk_bf16_f32 v148, v64, v65
  v_cvt_pk_bf16_f32 v149, v66, v67
  v_cvt_pk_bf16_f32 v150, v76, v77
  v_cvt_pk_bf16_f32 v151, v78, v79
  v_cvt_pk_bf16_f32 v152, v68, v69
  v_cvt_pk_bf16_f32 v153, v70, v71
  v_cvt_pk_bf16_f32 v154, v80, v81
  v_cvt_pk_bf16_f32 v155, v82, v83
  v_cvt_pk_bf16_f32 v156, v72, v73
  v_cvt_pk_bf16_f32 v157, v74, v75
  v_cvt_pk_bf16_f32 v158, v84, v85
  v_cvt_pk_bf16_f32 v159, v86, v87
  s_nop 1
  v_permlane16_swap_b32 v136, v138
  v_permlane16_swap_b32 v137, v139
  v_permlane16_swap_b32 v140, v142
  v_permlane16_swap_b32 v141, v143
  v_permlane16_swap_b32 v144, v146
  v_permlane16_swap_b32 v145, v147
  v_permlane16_swap_b32 v148, v150
  v_permlane16_swap_b32 v149, v151
  v_permlane16_swap_b32 v152, v154
  v_permlane16_swap_b32 v153, v155
  v_permlane16_swap_b32 v156, v158
  v_permlane16_swap_b32 v157, v159
  s_mov_b64 exec, 1
  ds_add_u32 v24, v25 offset:0
  s_mov_b64 exec, -1
  v_lshrrev_b32 v2, 2, v1
  v_and_b32 v3, 3, v1
  v_and_b32 v4, 7, v2
  v_lshlrev_b32 v3, 3, v3
  v_lshl_add_u32 v3, v4, 5, v3
  v_lshl_add_u32 v3, v2, 8, v3
  v_add_u32 v18, s76, v3
  v_xor_b32 v4, 32, v3
  v_add_u32 v19, s76, v4
  v_xor_b32 v4, 64, v3
  v_add_u32 v20, s76, v4
  v_xor_b32 v4, 96, v3
  v_add_u32 v21, s76, v4
  v_xor_b32 v4, 128, v3
  v_add_u32 v6, s76, v4
  v_xor_b32 v4, 160, v3
  v_add_u32 v7, s76, v4
  v_xor_b32 v4, 192, v3
  v_add_u32 v38, s76, v4
  v_xor_b32 v4, 224, v3
  v_add_u32 v39, s76, v4
  s_call_b64 s[8:9], L_attn_zero
L_spin_2:
  ds_read_b32 v2, v0 offset:48
  s_waitcnt lgkmcnt(0)
  v_readfirstlane_b32 s74, v2
  s_nop 0
  s_cmp_ge_u32 s74, 1
  s_cbranch_scc1 L_spun_3
  s_sleep 1
  s_branch L_spin_2
L_spun_3:
  v_lshlrev_b32 v37, 4, v1
  s_lshl_b32 s75, s4, 13
  v_add_u32 v22, s75, v37
  ds_read_b128 v[160:163], v22 offset:0
  ds_read_b128 v[164:167], v22 offset:1024
  ds_read_b128 v[168:171], v22 offset:2048
  ds_read_b128 v[172:175], v22 offset:3072
  ds_read_b128 v[176:179], v22 offset:4096
  ds_read_b128 v[180:183], v22 offset:5120
  s_waitcnt lgkmcnt(0)
  s_mov_b64 exec, 1
  ds_add_u32 v0, v25 offset:32
  s_mov_b64 exec, -1
  s_mov_b32 s72, 15
L_attnB_4:
  s_waitcnt vmcnt(8)
  ds_read_b128 v[224:227], v14 offset:0
  ds_read_b128 v[228:231], v15 offset:0
  ds_read_b128 v[232:235], v16 offset:0
  ds_read_b128 v[236:239], v17 offset:0
  ds_read_b128 v[240:243], v14 offset:4096
  ds_read_b128 v[244:247], v15 offset:4096
  ds_read_b128 v[248:251], v16 offset:4096
  ds_read_b128 v[252:255], v17 offset:4096
  s_waitcnt lgkmcnt(0)
  v_mfma_f32_16x16x32_bf16 v[200:203], v[224:227], v[136:139], 0
  v_mfma_f32_16x16x32_bf16 v[200:203], v[228:231], v[148:151], v[200:203]
  v_mfma_f32_16x16x32_bf16 v[200:203], v[232:235], v[160:163], v[200:203]
  v_mfma_f32_16x16x32_bf16 v[200:203], v[236:239], v[172:175], v[200:203]
  v_mfma_f32_16x16x32_bf16 v[212:215], v[240:243], v[136:139], 0
  v_mfma_f32_16x16x32_bf16 v[212:215], v[244:247], v[148:151], v[212:215]
  v_mfma_f32_16x16x32_bf16 v[212:215], v[248:251], v[160:163], v[212:215]
  v_mfma_f32_16x16x32_bf16 v[212:215], v[252:255], v[172:175], v[212:215]
  v_mfma_f32_16x16x32_bf16 v[204:207], v[224:227], v[140:143], 0
  v_mfma_f32_16x16x32_bf16 v[204:207], v[228:231], v[152:155], v[204:207]
  v_mfma_f32_16x16x32_bf16 v[204:207], v[232:235], v[164:167], v[204:207]
  v_mfma_f32_16x16x32_bf16 v[204:207], v[236:239], v[176:179], v[204:207]
  s_lshl_b32 s67, s81, 13
  s_add_u32 s67, s67, s83
  s_mov_b32 s68, s67
L_pz_5:
  ds_read_b32 v2, v24 offset:64
  s_waitcnt lgkmcnt(0)
  v_readfirstlane_b32 s74, v2
  s_nop 0
  s_and_b32 s75, s74, 7
  s_cbranch_scc0 L_pzd_6
L_pzs_8:
  s_sleep 4
  s_branch L_pz_5
L_pzd_6:
  s_cmp_eq_u32 s74, 8
  s_cselect_b32 s74, 1, s79
  s_cmp_eq_u32 s74, 0
  s_cbranch_scc1 L_pzt_7
  s_waitcnt vmcnt(0)
L_pzt_7:
  s_mov_b32 m0, s76
  s_nop 0
  buffer_load_dwordx4 v8, s[16:19], s67 offen nt lds
  buffer_load_dwordx4 v9, s[16:19], s67 offen offset:1024 nt lds
  buffer_load_dwordx4 v8, s[16:19], s67 offen offset:2048 nt lds
  buffer_load_dwordx4 v9, s[16:19], s67 offen offset:3072 nt lds
  s_add_u32 s67, s67, 4096
  s_add_u32 m0, s76, 4096
  s_nop 0
  buffer_load_dwordx4 v8, s[16:19], s67 offen nt lds
  buffer_load_dwordx4 v9, s[16:19], s67 offen offset:1024 nt lds
  buffer_load_dwordx4 v8, s[16:19], s67 offen offset:2048 nt lds
  buffer_load_dwordx4 v9, s[16:19], s67 offen offset:3072 nt lds
  s_add_u32 s81, s81, 1
  s_and_b32 s81, s81, 15
  v_mfma_f32_16x16x32_bf16 v[216:219], v[240:243], v[140:143], 0
  v_max3_f32 v32, v200, v201, v202
  v_max3_f32 v35, v203, v212, v213
  v_mfma_f32_16x16x32_bf16 v[216:219], v[244:247], v[152:155], v[216:219]
  v_max3_f32 v32, v32, v214, v215
  v_max_f32 v32, v32, v35
  v_mfma_f32_16x16x32_bf16 v[216:219], v[248:251], v[164:167], v[216:219]
  v_fma_f32 v35, v32, s66, v26
  v_cmp_lt_f32 vcc, s78, v35
  s_cbranch_vccz L_fast_9
  s_call_b64 s[8:9], L_rescale0
L_fast_9:
  v_mfma_f32_16x16x32_bf16 v[216:219], v[252:255], v[176:179], v[216:219]
  v_fma_f32 v200, v200, s66, v26
  v_fma_f32 v201, v201, s66, v26
  v_mfma_f32_16x16x32_bf16 v[208:211], v[224:227], v[144:147], 0
  v_exp_f32 v200, v200
  v_mfma_f32_16x16x32_bf16 v[208:211], v[228:231], v[156:159], v[208:211]
  v_fma_f32 v202, v202, s66, v26
  v_exp_f32 v201, v201
  v_mfma_f32_16x16x32_bf16 v[208:211], v[232:235], v[168:171], v[208:211]
  v_fma_f32 v203, v203, s66, v26
  v_exp_f32 v202, v202
  v_mfma_f32_16x16x32_bf16 v[208:211], v[236:239], v[180:183], v[208:211]
  v_fma_f32 v212, v212, s66, v26
  v_exp_f32 v203, v203
  v_mfma_f32_16x16x32_bf16 v[220:223], v[240:243], v[144:147], 0
  v_fma_f32 v213, v213, s66, v26
  v_exp_f32 v212, v212
  v_mfma_f32_16x16x32_bf16 v[220:223], v[244:247], v[156:159], v[220:223]
  v_fma_f32 v214, v214, s66, v26
  v_exp_f32 v213, v213
  v_mfma_f32_16x16x32_bf16 v[220:223], v[248:251], v[168:171], v[220:223]
  v_fma_f32 v215, v215, s66, v26
  v_exp_f32 v214, v214
  v_mfma_f32_16x16x32_bf16 v[220:223], v[252:255], v[180:183], v[220:223]
  v_add_f32 v32, v200, v201
  v_exp_f32 v215, v215
  v_add_f32 v35, v202, v203
  v_add_f32 v29, v29, v212
  v_add_f32 v32, v32, v213
  v_add_f32 v35, v35, v214
  v_add_f32 v29, v29, v215
  v_cvt_pk_bf16_f32 v200, v200, v201
  v_add_f32 v32, v32, v35
  v_cvt_pk_bf16_f32 v201, v202, v203
  v_cvt_pk_bf16_f32 v202, v212, v213
  v_add_f32 v29, v29, v32
  v_cvt_pk_bf16_f32 v203, v214, v215
  v_max3_f32 v33, v204, v205, v206
  v_max3_f32 v36, v207, v216, v217
  v_max3_f32 v33, v33, v218, v219
  v_max_f32 v33, v33, v36
  v_fma_f32 v36, v33, s66, v27
  v_cmp_lt_f32 vcc, s78, v36
  s_cbranch_vccz L_fast_10
  s_call_b64 s[8:9], L_rescale1
L_fast_10:
  v_fma_f32 v204, v204, s66, v27
  v_fma_f32 v205, v205, s66, v27
  v_exp_f32 v204, v204
  v_fma_f32 v206, v206, s66, v27
  v_exp_f32 v205, v205
  v_fma_f32 v207, v207, s66, v27
  v_exp_f32 v206, v206
  v_fma_f32 v216, v216, s66, v27
  v_exp_f32 v207, v207
  v_fma_f32 v217, v217, s66, v27
  v_exp_f32 v216, v216
  v_fma_f32 v218, v218, s66, v27
  v_exp_f32 v217, v217
  v_fma_f32 v219, v219, s66, v27
  v_exp_f32 v218, v218
  v_add_f32 v33, v204, v205
  v_exp_f32 v219, v219
  v_add_f32 v36, v206, v207
  v_add_f32 v30, v30, v216
  v_add_f32 v33, v33, v217
  v_add_f32 v36, v36, v218
  v_add_f32 v30, v30, v219
  v_cvt_pk_bf16_f32 v204, v204, v205
  v_add_f32 v33, v33, v36
  v_cvt_pk_bf16_f32 v205, v206, v207
  v_cvt_pk_bf16_f32 v206, v216, v217
  v_add_f32 v30, v30, v33
  v_cvt_pk_bf16_f32 v207, v218, v219
  v_max3_f32 v34, v208, v209, v210
  v_max3_f32 v37, v211, v220, v221
  v_max3_f32 v34, v34, v222, v223
  v_max_f32 v34, v34, v37
  v_fma_f32 v37, v34, s66, v28
  v_cmp_lt_f32 vcc, s78, v37
  s_cbranch_vccz L_fast_11
  s_call_b64 s[8:9], L_rescale2
L_fast_11:
  v_fma_f32 v208, v208, s66, v28
  v_fma_f32 v209, v209, s66, v28
  v_exp_f32 v208, v208
  v_fma_f32 v210, v210, s66, v28
  v_exp_f32 v209, v209
  v_fma_f32 v211, v211, s66, v28
  v_exp_f32 v210, v210
  v_fma_f32 v220, v220, s66, v28
  v_exp_f32 v211, v211
  v_fma_f32 v221, v221, s66, v28
  v_exp_f32 v220, v220
  v_fma_f32 v222, v222, s66, v28
  v_exp_f32 v221, v221
  v_fma_f32 v223, v223, s66, v28
  v_exp_f32 v222, v222
  v_add_f32 v34, v208, v209
  v_exp_f32 v223, v223
  v_add_f32 v37, v210, v211
  v_add_f32 v31, v31, v220
  v_add_f32 v34, v34, v221
  v_add_f32 v37, v37, v222
  v_add_f32 v31, v31, v223
  v_cvt_pk_bf16_f32 v208, v208, v209
  v_add_f32 v34, v34, v37
  v_cvt_pk_bf16_f32 v209, v210, v211
  v_cvt_pk_bf16_f32 v210, v220, v221
  v_add_f32 v31, v31, v34
  v_cvt_pk_bf16_f32 v211, v222, v223
  s_waitcnt vmcnt(8)
  ds_read_b64_tr_b16 v[224:225], v18 offset:8192
  ds_read_b64_tr_b16 v[228:229], v19 offset:8192
  ds_read_b64_tr_b16 v[232:233], v20 offset:8192
  ds_read_b64_tr_b16 v[236:237], v21 offset:8192
  ds_read_b64_tr_b16 v[240:241], v6 offset:8192
  ds_read_b64_tr_b16 v[244:245], v7 offset:8192
  ds_read_b64_tr_b16 v[248:249], v38 offset:8192
  ds_read_b64_tr_b16 v[252:253], v39 offset:8192
  ds_read_b64_tr_b16 v[226:227], v18 offset:12288
  ds_read_b64_tr_b16 v[230:231], v19 offset:12288
  ds_read_b64_tr_b16 v[234:235], v20 offset:12288
  ds_read_b64_tr_b16 v[238:239], v21 offset:12288
  ds_read_b64_tr_b16 v[242:243], v6 offset:12288
  ds_read_b64_tr_b16 v[246:247], v7 offset:12288
  ds_read_b64_tr_b16 v[250:251], v38 offset:12288
  ds_read_b64_tr_b16 v[254:255], v39 offset:12288
  s_waitcnt lgkmcnt(0)
L_pz_12:
  ds_read_b32 v2, v24 offset:64
  s_waitcnt lgkmcnt(0)
  v_readfirstlane_b32 s74, v2
  s_nop 0
  s_and_b32 s75, s74, 7
  s_cbranch_scc0 L_pzd_13
L_pzs_15:
  s_sleep 4
  s_branch L_pz_12
L_pzd_13:
  s_cmp_eq_u32 s74, 8
  s_cselect_b32 s74, 1, s79
  s_cmp_eq_u32 s74, 0
  s_cbranch_scc1 L_pzt_14
  s_waitcnt vmcnt(0)
L_pzt_14:
  s_add_u32 m0, s76, 8192
  s_nop 0
  buffer_load_dwordx4 v8, s[20:23], s68 offen nt lds
  buffer_load_dwordx4 v9, s[20:23], s68 offen offset:1024 nt lds
  buffer_load_dwordx4 v8, s[20:23], s68 offen offset:2048 nt lds
  buffer_load_dwordx4 v9, s[20:23], s68 offen offset:3072 nt lds
  s_add_u32 s68, s68, 4096
  s_add_u32 m0, s76, 12288
  s_nop 0
  buffer_load_dwordx4 v8, s[20:23], s68 offen nt lds
  buffer_load_dwordx4 v9, s[20:23], s68 offen offset:1024 nt lds
  buffer_load_dwordx4 v8, s[20:23], s68 offen offset:2048 nt lds
  buffer_load_dwordx4 v9, s[20:23], s68 offen offset:3072 nt lds
  s_mov_b64 exec, 1
  ds_add_u32 v24, v25 offset:68
  s_mov_b64 exec, -1
  v_mfma_f32_16x16x32_bf16 v[40:43], v[224:227], v[200:203], v[40:43]
  v_mfma_f32_16x16x32_bf16 v[52:55], v[228:231], v[200:203], v[52:55]
  v_mfma_f32_16x16x32_bf16 v[64:67], v[232:235], v[200:203], v[64:67]
  v_mfma_f32_16x16x32_bf16 v[76:79], v[236:239], v[200:203], v[76:79]
  v_mfma_f32_16x16x32_bf16 v[88:91], v[240:243], v[200:203], v[88:91]
  v_mfma_f32_16x16x32_bf16 v[100:103], v[244:247], v[200:203], v[100:103]
  v_mfma_f32_16x16x32_bf16 v[112:115], v[248:251], v[200:203], v[112:115]
  v_mfma_f32_16x16x32_bf16 v[124:127], v[252:255], v[200:203], v[124:127]
  v_mfma_f32_16x16x32_bf16 v[44:47], v[224:227], v[204:207], v[44:47]
  v_mfma_f32_16x16x32_bf16 v[56:59], v[228:231], v[204:207], v[56:59]
  v_mfma_f32_16x16x32_bf16 v[68:71], v[232:235], v[204:207], v[68:71]
  v_mfma_f32_16x16x32_bf16 v[80:83], v[236:239], v[204:207], v[80:83]
  v_mfma_f32_16x16x32_bf16 v[92:95], v[240:243], v[204:207], v[92:95]
  v_mfma_f32_16x16x32_bf16 v[104:107], v[244:247], v[204:207], v[104:107]
  v_mfma_f32_16x16x32_bf16 v[116:119], v[248:251], v[204:207], v[116:119]
  v_mfma_f32_16x16x32_bf16 v[128:131], v[252:255], v[204:207], v[128:131]
  v_mfma_f32_16x16x32_bf16 v[48:51], v[224:227], v[208:211], v[48:51]
  v_mfma_f32_16x16x32_bf16 v[60:63], v[228:231], v[208:211], v[60:63]
  v_mfma_f32_16x16x32_bf16 v[72:75], v[232:235], v[208:211], v[72:75]
  v_mfma_f32_16x16x32_bf16 v[84:87], v[236:239], v[208:211], v[84:87]
  v_mfma_f32_16x16x32_bf16 v[96:99], v[240:243], v[208:211], v[96:99]
  v_mfma_f32_16x16x32_bf16 v[108:111], v[244:247], v[208:211], v[108:111]
  v_mfma_f32_16x16x32_bf16 v[120:123], v[248:251], v[208:211], v[120:123]
  v_mfma_f32_16x16x32_bf16 v[132:135], v[252:255], v[208:211], v[132:135]
  s_sub_u32 s72, s72, 1
  s_cmp_lg_u32 s72, 0
  s_cbranch_scc1 L_attnB_4
  v_lshrrev_b32 v2, 5, v1
  v_bfe_u32 v3, v1, 3, 2
  v_lshl_add_u32 v3, v2, 3, v3
  v_lshlrev_b32 v3, 10, v3
  v_and_b32 v4, 7, v1
  v_lshrrev_b32 v2, 4, v1
  v_lshlrev_b32 v2, 1, v2
  v_xor_b32 v4, v4, v2
  v_lshl_add_u32 v10, v4, 4, v3
  v_add_u32 v11, 15360, v10
  v_add_u32 v12, 2048, v10
  v_add_u32 v13, 17408, v10
  s_mov_b32 s24, s58
  s_mov_b32 s25, s59
  s_mov_b32 s26, 4194304
  s_mov_b32 s27, 0x20000
  s_lshl_b32 s69, s6, 19
  s_lshl_b32 s74, s4, 8
  s_add_u32 s69, s69, s74
  s_lshl_b32 s74, s7, 7
  s_add_u32 s69, s69, s74
  s_mov_b32 s70, 0
  s_lshl_b32 s77, s4, 17
  s_mov_b32 s73, s76
  s_waitcnt vmcnt(8)
  ds_read_b128 v[224:227], v14 offset:0
  ds_read_b128 v[228:231], v15 offset:0
  ds_read_b128 v[232:235], v16 offset:0
  ds_read_b128 v[236:239], v17 offset:0
  ds_read_b128 v[240:243], v14 offset:4096
  ds_read_b128 v[244:247], v15 offset:4096
  ds_read_b128 v[248:251], v16 offset:4096
  ds_read_b128 v[252:255], v17 offset:4096
  s_waitcnt lgkmcnt(0)
  v_mfma_f32_16x16x32_bf16 v[200:203], v[224:227], v[136:139], 0
  v_mfma_f32_16x16x32_bf16 v[200:203], v[228:231], v[148:151], v[200:203]
  v_mfma_f32_16x16x32_bf16 v[200:203], v[232:235], v[160:163], v[200:203]
  v_mfma_f32_16x16x32_bf16 v[200:203], v[236:239], v[172:175], v[200:203]
  v_mfma_f32_16x16x32_bf16 v[212:215], v[240:243], v[136:139], 0
  v_mfma_f32_16x16x32_bf16 v[212:215], v[244:247], v[148:151], v[212:215]
  v_mfma_f32_16x16x32_bf16 v[212:215], v[248:251], v[160:163], v[212:215]
  v_mfma_f32_16x16x32_bf16 v[212:215], v[252:255], v[172:175], v[212:215]
  v_mfma_f32_16x16x32_bf16 v[204:207], v[224:227], v[140:143], 0
  v_mfma_f32_16x16x32_bf16 v[204:207], v[228:231], v[152:155], v[204:207]
  v_mfma_f32_16x16x32_bf16 v[204:207], v[232:235], v[164:167], v[204:207]
  v_mfma_f32_16x16x32_bf16 v[204:207], v[236:239], v[176:179], v[204:207]
  s_add_u32 s82, s77, s69
  s_add_u32 m0, s73, 0
  s_add_u32 s77, s77, 0x8000
  buffer_load_dwordx4 v10, s[24:27], s82 offen offset:0 lds
  buffer_load_dwordx4 v11, s[24:27], s82 offen offset:1024 lds
  buffer_load_dwordx4 v12, s[24:27], s82 offen offset:2048 lds
  buffer_load_dwordx4 v13, s[24:27], s82 offen offset:3072 lds
  s_and_b32 s77, s77, 0x7ffff
  s_add_u32 s70, s70, 1
  s_add_u32 s82, s77, s69
  s_add_u32 m0, s73, 4096
  s_add_u32 s77, s77, 0x8000
  buffer_load_dwordx4 v10, s[24:27], s82 offen offset:0 lds
  buffer_load_dwordx4 v11, s[24:27], s82 offen offset:1024 lds
  buffer_load_dwordx4 v12, s[24:27], s82 offen offset:2048 lds
  buffer_load_dwordx4 v13, s[24:27], s82 offen offset:3072 lds
  s_and_b32 s77, s77, 0x7ffff
  s_add_u32 s70, s70, 1
  v_mfma_f32_16x16x32_bf16 v[216:219], v[240:243], v[140:143], 0
  v_max3_f32 v32, v200, v201, v202
  v_max3_f32 v35, v203, v212, v213
  v_mfma_f32_16x16x32_bf16 v[216:219], v[244:247], v[152:155], v[216:219]
  v_max3_f32 v32, v32, v214, v215
  v_max_f32 v32, v32, v35
  v_mfma_f32_16x16x32_bf16 v[216:219], v[248:251], v[164:167], v[216:219]
  v_fma_f32 v35, v32, s66, v26
  v_cmp_lt_f32 vcc, s78, v35
  s_cbranch_vccz L_fast_18
  s_call_b64 s[8:9], L_rescale0
L_fast_18:
  v_mfma_f32_16x16x32_bf16 v[216:219], v[252:255], v[176:179], v[216:219]
  v_fma_f32 v200, v200, s66, v26
  v_fma_f32 v201, v201, s66, v26
  v_mfma_f32_16x16x32_bf16 v[208:211], v[224:227], v[144:147], 0
  v_exp_f32 v200, v200
  v_mfma_f32_16x16x32_bf16 v[208:211], v[228:231], v[156:159], v[208:211]
  v_fma_f32 v202, v202, s66, v26
  v_exp_f32 v201, v201
  v_mfma_f32_16x16x32_bf16 v[208:211], v[232:235], v[168:171], v[208:211]
  v_fma_f32 v203, v203, s66, v26
  v_exp_f32 v202, v202
  v_mfma_f32_16x16x32_bf16 v[208:211], v[236:239], v[180:183], v[208:211]
  v_fma_f32 v212, v212, s66, v26
  v_exp_f32 v203, v203
  v_mfma_f32_16x16x32_bf16 v[220:223], v[240:243], v[144:147], 0
  v_fma_f32 v213, v213, s66, v26
  v_exp_f32 v212, v212
  v_mfma_f32_16x16x32_bf16 v[220:223], v[244:247], v[156:159], v[220:223]
  v_fma_f32 v214, v214, s66, v26
  v_exp_f32 v213, v213
  v_mfma_f32_16x16x32_bf16 v[220:223], v[248:251], v[168:171], v[220:223]
  v_fma_f32 v215, v215, s66, v26
  v_exp_f32 v214, v214
  v_mfma_f32_16x16x32_bf16 v[220:223], v[252:255], v[180:183], v[220:223]
  v_add_f32 v32, v200, v201
  v_exp_f32 v215, v215
  v_add_f32 v35, v202, v203
  v_add_f32 v29, v29, v212
  v_add_f32 v32, v32, v213
  v_add_f32 v35, v35, v214
  v_add_f32 v29, v29, v215
  v_cvt_pk_bf16_f32 v200, v200, v201
  v_add_f32 v32, v32, v35
  v_cvt_pk_bf16_f32 v201, v202, v203
  v_cvt_pk_bf16_f32 v202, v212, v213
  v_add_f32 v29, v29, v32
  v_cvt_pk_bf16_f32 v203, v214, v215
  v_max3_f32 v33, v204, v205, v206
  v_max3_f32 v36, v207, v216, v217
  v_max3_f32 v33, v33, v218, v219
  v_max_f32 v33, v33, v36
  v_fma_f32 v36, v33, s66, v27
  v_cmp_lt_f32 vcc, s78, v36
  s_cbranch_vccz L_fast_19
  s_call_b64 s[8:9], L_rescale1
L_fast_19:
  v_fma_f32 v204, v204, s66, v27
  v_fma_f32 v205, v205, s66, v27
  v_exp_f32 v204, v204
  v_fma_f32 v206, v206, s66, v27
  v_exp_f32 v205, v205
  v_fma_f32 v207, v207, s66, v27
  v_exp_f32 v206, v206
  v_fma_f32 v216, v216, s66, v27
  v_exp_f32 v207, v207
  v_fma_f32 v217, v217, s66, v27
  v_exp_f32 v216, v216
  v_fma_f32 v218, v218, s66, v27
  v_exp_f32 v217, v217
  v_fma_f32 v219, v219, s66, v27
  v_exp_f32 v218, v218
  v_add_f32 v33, v204, v205
  v_exp_f32 v219, v219
  v_add_f32 v36, v206, v207
  v_add_f32 v30, v30, v216
  v_add_f32 v33, v33, v217
  v_add_f32 v36, v36, v218
  v_add_f32 v30, v30, v219
  v_cvt_pk_bf16_f32 v204, v204, v205
  v_add_f32 v33, v33, v36
  v_cvt_pk_bf16_f32 v205, v206, v207
  v_cvt_pk_bf16_f32 v206, v216, v217
  v_add_f32 v30, v30, v33
  v_cvt_pk_bf16_f32 v207, v218, v219
  v_max3_f32 v34, v208, v209, v210
  v_max3_f32 v37, v211, v220, v221
  v_max3_f32 v34, v34, v222, v223
  v_max_f32 v34, v34, v37
  v_fma_f32 v37, v34, s66, v28
  v_cmp_lt_f32 vcc, s78, v37
  s_cbranch_vccz L_fast_20
  s_call_b64 s[8:9], L_rescale2
L_fast_20:
  v_fma_f32 v208, v208, s66, v28
  v_fma_f32 v209, v209, s66, v28
  v_exp_f32 v208, v208
  v_fma_f32 v210, v210, s66, v28
  v_exp_f32 v209, v209
  v_fma_f32 v211, v211, s66, v28
  v_exp_f32 v210, v210
  v_fma_f32 v220, v220, s66, v28
  v_exp_f32 v211, v211
  v_fma_f32 v221, v221, s66, v28
  v_exp_f32 v220, v220
  v_fma_f32 v222, v222, s66, v28
  v_exp_f32 v221, v221
  v_fma_f32 v223, v223, s66, v28
  v_exp_f32 v222, v222
  v_add_f32 v34, v208, v209
  v_exp_f32 v223, v223
  v_add_f32 v37, v210, v211
  v_add_f32 v31, v31, v220
  v_add_f32 v34, v34, v221
  v_add_f32 v37, v37, v222
  v_add_f32 v31, v31, v223
  v_cvt_pk_bf16_f32 v208, v208, v209
  v_add_f32 v34, v34, v37
  v_cvt_pk_bf16_f32 v209, v210, v211
  v_cvt_pk_bf16_f32 v210, v220, v221
  v_add_f32 v31, v31, v34
  v_cvt_pk_bf16_f32 v211, v222, v223
  s_waitcnt vmcnt(8)
  ds_read_b64_tr_b16 v[224:225], v18 offset:8192
  ds_read_b64_tr_b16 v[228:229], v19 offset:8192
  ds_read_b64_tr_b16 v[232:233], v20 offset:8192
  ds_read_b64_tr_b16 v[236:237], v21 offset:8192
  ds_read_b64_tr_b16 v[240:241], v6 offset:8192
  ds_read_b64_tr_b16 v[244:245], v7 offset:8192
  ds_read_b64_tr_b16 v[248:249], v38 offset:8192
  ds_read_b64_tr_b16 v[252:253], v39 offset:8192
  ds_read_b64_tr_b16 v[226:227], v18 offset:12288
  ds_read_b64_tr_b16 v[230:231], v19 offset:12288
  ds_read_b64_tr_b16 v[234:235], v20 offset:12288
  ds_read_b64_tr_b16 v[238:239], v21 offset:12288
  ds_read_b64_tr_b16 v[242:243], v6 offset:12288
  ds_read_b64_tr_b16 v[246:247], v7 offset:12288
  ds_read_b64_tr_b16 v[250:251], v38 offset:12288
  ds_read_b64_tr_b16 v[254:255], v39 offset:12288
  s_waitcnt lgkmcnt(0)
  s_add_u32 s82, s77, s69
  s_add_u32 m0, s73, 8192
  s_add_u32 s77, s77, 0x8000
  buffer_load_dwordx4 v10, s[24:27], s82 offen offset:0 lds
  buffer_load_dwordx4 v11, s[24:27], s82 offen offset:1024 lds
  buffer_load_dwordx4 v12, s[24:27], s82 offen offset:2048 lds
  buffer_load_dwordx4 v13, s[24:27], s82 offen offset:3072 lds
  s_and_b32 s77, s77, 0x7ffff
  s_add_u32 s70, s70, 1
  s_add_u32 s82, s77, s69
  s_add_u32 m0, s73, 12288
  s_add_u32 s77, s77, 0x8000
  buffer_load_dwordx4 v10, s[24:27], s82 offen offset:0 lds
  buffer_load_dwordx4 v11, s[24:27], s82 offen offset:1024 lds
  buffer_load_dwordx4 v12, s[24:27], s82 offen offset:2048 lds
  buffer_load_dwordx4 v13, s[24:27], s82 offen offset:3072 lds
  s_and_b32 s77, s77, 0x7ffff
  s_add_u32 s70, s70, 1
  v_mfma_f32_16x16x32_bf16 v[40:43], v[224:227], v[200:203], v[40:43]
  v_mfma_f32_16x16x32_bf16 v[52:55], v[228:231], v[200:203], v[52:55]
  v_mfma_f32_16x16x32_bf16 v[64:67], v[232:235], v[200:203], v[64:67]
  v_mfma_f32_16x16x32_bf16 v[76:79], v[236:239], v[200:203], v[76:79]
  v_mfma_f32_16x16x32_bf16 v[88:91], v[240:243], v[200:203], v[88:91]
  v_mfma_f32_16x16x32_bf16 v[100:103], v[244:247], v[200:203], v[100:103]
  v_mfma_f32_16x16x32_bf16 v[112:115], v[248:251], v[200:203], v[112:115]
  v_mfma_f32_16x16x32_bf16 v[124:127], v[252:255], v[200:203], v[124:127]
  v_mfma_f32_16x16x32_bf16 v[44:47], v[224:227], v[204:207], v[44:47]
  v_mfma_f32_16x16x32_bf16 v[56:59], v[228:231], v[204:207], v[56:59]
  v_mfma_f32_16x16x32_bf16 v[68:71], v[232:235], v[204:207], v[68:71]
  v_mfma_f32_16x16x32_bf16 v[80:83], v[236:239], v[204:207], v[80:83]
  v_mfma_f32_16x16x32_bf16 v[92:95], v[240:243], v[204:207], v[92:95]
  v_mfma_f32_16x16x32_bf16 v[104:107], v[244:247], v[204:207], v[104:107]
  v_mfma_f32_16x16x32_bf16 v[116:119], v[248:251], v[204:207], v[116:119]
  v_mfma_f32_16x16x32_bf16 v[128:131], v[252:255], v[204:207], v[128:131]
  v_mfma_f32_16x16x32_bf16 v[48:51], v[224:227], v[208:211], v[48:51]
  v_mfma_f32_16x16x32_bf16 v[60:63], v[228:231], v[208:211], v[60:63]
  v_mfma_f32_16x16x32_bf16 v[72:75], v[232:235], v[208:211], v[72:75]
  v_mfma_f32_16x16x32_bf16 v[84:87], v[236:239], v[208:211], v[84:87]
  v_mfma_f32_16x16x32_bf16 v[96:99], v[240:243], v[208:211], v[96:99]
  v_mfma_f32_16x16x32_bf16 v[108:111], v[244:247], v[208:211], v[108:111]
  v_mfma_f32_16x16x32_bf16 v[120:123], v[248:251], v[208:211], v[120:123]
  v_mfma_f32_16x16x32_bf16 v[132:135], v[252:255], v[208:211], v[132:135]
  v_lshrrev_b32 v2, 2, v1
  v_and_b32 v3, 3, v1
  v_bfe_u32 v4, v1, 3, 2
  v_lshlrev_b32 v3, 3, v3
  v_lshl_add_u32 v3, v4, 5, v3
  v_lshl_add_u32 v3, v2, 7, v3
  v_add_u32 v18, s73, v3
  v_xor_b32 v4, 32, v3
  v_add_u32 v19, s73, v4
  v_xor_b32 v4, 64, v3
  v_add_u32 v20, s73, v4
  v_xor_b32 v4, 96, v3
  v_add_u32 v21, s73, v4
  s_call_b64 s[8:9], L_attn_finish
L_spin_23:
  ds_read_b32 v2, v24 offset:4
  s_waitcnt lgkmcnt(0)
  v_readfirstlane_b32 s74, v2
  s_nop 0
  s_cmp_ge_u32 s74, 80
  s_cbranch_scc1 L_spun_24
  s_sleep 2
  s_branch L_spin_23
L_spun_24:
  ds_write_b128 v22, v[136:139] offset:0
  ds_write_b128 v22, v[140:143] offset:2048
  ds_write_b128 v22, v[144:147] offset:4096
  ds_write_b128 v5, v[148:151] offset:0
  ds_write_b128 v5, v[152:155] offset:2048
  ds_write_b128 v5, v[156:159] offset:4096
  ds_write_b128 v22, v[160:163] offset:6144
  ds_write_b128 v22, v[164:167] offset:8192
  ds_write_b128 v22, v[168:171] offset:10240
  ds_write_b128 v5, v[172:175] offset:6144
  ds_write_b128 v5, v[176:179] offset:8192
  ds_write_b128 v5, v[180:183] offset:10240
  s_waitcnt lgkmcnt(0)
  s_mov_b64 exec, 1
  ds_add_u32 v0, v25 offset:80
  s_mov_b64 exec, -1
  s_call_b64 s[8:9], L_tail4
  s_branch L_tail
L_teamA:
  s_waitcnt vmcnt(0)
  s_mul_i32 s77, s70, 262144
  s_add_u32 s77, s77, s69
  s_add_u32 m0, s73, 4096
  s_nop 0
  buffer_load_dwordx4 v10, s[24:27], s77 offen lds
  buffer_load_dwordx4 v11, s[24:27], s77 offen offset:1024 lds
  buffer_load_dwordx4 v12, s[24:27], s77 offen offset:2048 lds
  buffer_load_dwordx4 v13, s[24:27], s77 offen offset:3072 lds
  s_add_u32 s70, s70, 1
  s_and_b32 s70, s70, 15
  s_barrier
  s_setprio 1
  v_mov_b32 v40, 0
  v_mov_b32 v41, 0
  v_mov_b32 v42, 0
  v_mov_b32 v43, 0
  v_mov_b32 v44, 0
  v_mov_b32 v45, 0
  v_mov_b32 v46, 0
  v_mov_b32 v47, 0
  v_mov_b32 v48, 0
  v_mov_b32 v49, 0
  v_mov_b32 v50, 0
  v_mov_b32 v51, 0
  v_mov_b32 v52, 0
  v_mov_b32 v53, 0
  v_mov_b32 v54, 0
  v_mov_b32 v55, 0
  v_mov_b32 v56, 0
  v_mov_b32 v57, 0
  v_mov_b32 v58, 0
  v_mov_b32 v59, 0
  v_mov_b32 v60, 0
  v_mov_b32 v61, 0
  v_mov_b32 v62, 0
  v_mov_b32 v63, 0
  v_mov_b32 v64, 0
  v_mov_b32 v65, 0
  v_mov_b32 v66, 0
  v_mov_b32 v67, 0
  v_mov_b32 v68, 0
  v_mov_b32 v69, 0
  v_mov_b32 v70, 0
  v_mov_b32 v71, 0
  v_mov_b32 v72, 0
  v_mov_b32 v73, 0
  v_mov_b32 v74, 0
  v_mov_b32 v75, 0
  v_mov_b32 v76, 0
  v_mov_b32 v77, 0
  v_mov_b32 v78, 0
  v_mov_b32 v79, 0
  v_mov_b32 v80, 0
  v_mov_b32 v81, 0
  v_mov_b32 v82, 0
  v_mov_b32 v83, 0
  v_mov_b32 v84, 0
  v_mov_b32 v85, 0
  v_mov_b32 v86, 0
  v_mov_b32 v87, 0
  s_and_b32 s74, s71, 1
  s_lshl_b32 s74, s74, 6
  s_lshr_b32 s75, s71, 1
  v_xor_b32 v22, s74, v23
  s_mul_i32 s75, s75, 6144
  v_add_u32 v22, s75, v22
  s_add_u32 s71, s71, 1
  s_and_b32 s71, s71, 15
  s_waitcnt vmcnt(4)
  ds_read_b64_tr_b16 v[136:137], v18 offset:0
  ds_read_b64_tr_b16 v[140:141], v19 offset:0
  ds_read_b64_tr_b16 v[144:145], v20 offset:0
  ds_read_b64_tr_b16 v[148:149], v21 offset:0
  ds_read_b64_tr_b16 v[138:139], v18 offset:2048
  ds_read_b64_tr_b16 v[142:143], v19 offset:2048
  ds_read_b64_tr_b16 v[146:147], v20 offset:2048
  ds_read_b64_tr_b16 v[150:151], v21 offset:2048
  ds_read_b128 v[200:203], v22 offset:0
  ds_read_b128 v[204:207], v22 offset:2048
  ds_read_b128 v[208:211], v22 offset:4096
  s_waitcnt lgkmcnt(0)
  s_mul_i32 s77, s70, 262144
  s_add_u32 s77, s77, s69
  s_mov_b32 m0, s73
  s_nop 0
  buffer_load_dwordx4 v10, s[24:27], s77 offen lds
  buffer_load_dwordx4 v11, s[24:27], s77 offen offset:1024 lds
  buffer_load_dwordx4 v12, s[24:27], s77 offen offset:2048 lds
  buffer_load_dwordx4 v13, s[24:27], s77 offen offset:3072 lds
  s_add_u32 s70, s70, 1
  s_and_b32 s70, s70, 15
  s_and_b32 s74, s71, 1
  s_lshl_b32 s74, s74, 6
  s_lshr_b32 s75, s71, 1
  v_xor_b32 v22, s74, v23
  s_mul_i32 s75, s75, 6144
  v_add_u32 v22, s75, v22
  s_add_u32 s71, s71, 1
  s_and_b32 s71, s71, 15
  s_waitcnt vmcnt(4)
  ds_read_b64_tr_b16 v[168:169], v18 offset:4096
  ds_read_b64_tr_b16 v[172:173], v19 offset:4096
  ds_read_b64_tr_b16 v[176:177], v20 offset:4096
  ds_read_b64_tr_b16 v[180:181], v21 offset:4096
  ds_read_b64_tr_b16 v[170:171], v18 offset:6144
  ds_read_b64_tr_b16 v[174:175], v19 offset:6144
  ds_read_b64_tr_b16 v[178:179], v20 offset:6144
  ds_read_b64_tr_b16 v[182:183], v21 offset:6144
  ds_read_b128 v[212:215], v22 offset:0
  ds_read_b128 v[216:219], v22 offset:2048
  ds_read_b128 v[220:223], v22 offset:4096
  v_mfma_f32_16x16x32_bf16 v[40:43], v[136:139], v[200:203], v[40:43]
  v_mfma_f32_16x16x32_bf16 v[44:47], v[136:139], v[204:207], v[44:47]
  v_mfma_f32_16x16x32_bf16 v[48:51], v[136:139], v[208:211], v[48:51]
  v_mfma_f32_16x16x32_bf16 v[52:55], v[140:143], v[200:203], v[52:55]
  v_mfma_f32_16x16x32_bf16 v[56:59], v[140:143], v[204:207], v[56:59]
  v_mfma_f32_16x16x32_bf16 v[60:63], v[140:143], v[208:211], v[60:63]
  s_waitcnt lgkmcnt(0)
  s_mul_i32 s77, s70, 262144
  s_add_u32 s77, s77, s69
  s_add_u32 m0, s73, 4096
  s_nop 0
  buffer_load_dwordx4 v10, s[24:27], s77 offen lds
  buffer_load_dwordx4 v11, s[24:27], s77 offen offset:1024 lds
  buffer_load_dwordx4 v12, s[24:27], s77 offen offset:2048 lds
  buffer_load_dwordx4 v13, s[24:27], s77 offen offset:3072 lds
  s_add_u32 s70, s70, 1
  s_and_b32 s70, s70, 15
  v_mfma_f32_16x16x32_bf16 v[64:67], v[144:147], v[200:203], v[64:67]
  v_mfma_f32_16x16x32_bf16 v[68:71], v[144:147], v[204:207], v[68:71]
  v_mfma_f32_16x16x32_bf16 v[72:75], v[144:147], v[208:211], v[72:75]
  v_mfma_f32_16x16x32_bf16 v[76:79], v[148:151], v[200:203], v[76:79]
  v_mfma_f32_16x16x32_bf16 v[80:83], v[148:151], v[204:207], v[80:83]
  v_mfma_f32_16x16x32_bf16 v[84:87], v[148:151], v[208:211], v[84:87]
  s_mov_b32 s72, 5
L_qb_25:
  s_and_b32 s74, s71, 1
  s_lshl_b32 s74, s74, 6
  s_lshr_b32 s75, s71, 1
  v_xor_b32 v22, s74, v23
  s_mul_i32 s75, s75, 6144
  v_add_u32 v22, s75, v22
  s_add_u32 s71, s71, 1
  s_and_b32 s71, s71, 15
  s_waitcnt vmcnt(4)
  ds_read_b64_tr_b16 v[136:137], v18 offset:0
  ds_read_b64_tr_b16 v[140:141], v19 offset:0
  ds_read_b64_tr_b16 v[144:145], v20 offset:0
  ds_read_b64_tr_b16 v[148:149], v21 offset:0
  ds_read_b64_tr_b16 v[138:139], v18 offset:2048
  ds_read_b64_tr_b16 v[142:143], v19 offset:2048
  ds_read_b64_tr_b16 v[146:147], v20 offset:2048
  ds_read_b64_tr_b16 v[150:151], v21 offset:2048
  ds_read_b128 v[200:203], v22 offset:0
  ds_read_b128 v[204:207], v22 offset:2048
  ds_read_b128 v[208:211], v22 offset:4096
  v_mfma_f32_16x16x32_bf16 v[40:43], v[168:171], v[212:215], v[40:43]
  v_mfma_f32_16x16x32_bf16 v[44:47], v[168:171], v[216:219], v[44:47]
  v_mfma_f32_16x16x32_bf16 v[48:51], v[168:171], v[220:223], v[48:51]
  v_mfma_f32_16x16x32_bf16 v[52:55], v[172:175], v[212:215], v[52:55]
  v_mfma_f32_16x16x32_bf16 v[56:59], v[172:175], v[216:219], v[56:59]
  v_mfma_f32_16x16x32_bf16 v[60:63], v[172:175], v[220:223], v[60:63]
  s_waitcnt lgkmcnt(0)
  s_mul_i32 s77, s70, 262144
  s_add_u32 s77, s77, s69
  s_mov_b32 m0, s73
  s_nop 0
  buffer_load_dwordx4 v10, s[24:27], s77 offen lds
  buffer_load_dwordx4 v11, s[24:27], s77 offen offset:1024 lds
  buffer_load_dwordx4 v12, s[24:27], s77 offen offset:2048 lds
  buffer_load_dwordx4 v13, s[24:27], s77 offen offset:3072 lds
  s_add_u32 s70, s70, 1
  s_and_b32 s70, s70, 15
  v_mfma_f32_16x16x32_bf16 v[64:67], v[176:179], v[212:215], v[64:67]
  v_mfma_f32_16x16x32_bf16 v[68:71], v[176:179], v[216:219], v[68:71]
  v_mfma_f32_16x16x32_bf16 v[72:75], v[176:179], v[220:223], v[72:75]
  v_mfma_f32_16x16x32_bf16 v[76:79], v[180:183], v[212:215], v[76:79]
  v_mfma_f32_16x16x32_bf16 v[80:83], v[180:183], v[216:219], v[80:83]
  v_mfma_f32_16x16x32_bf16 v[84:87], v[180:183], v[220:223], v[84:87]
  s_and_b32 s74, s71, 1
  s_lshl_b32 s74, s74, 6
  s_lshr_b32 s75, s71, 1
  v_xor_b32 v22, s74, v23
  s_mul_i32 s75, s75, 6144
  v_add_u32 v22, s75, v22
  s_add_u32 s71, s71, 1
  s_and_b32 s71, s71, 15
  s_waitcnt vmcnt(4)
  ds_read_b64_tr_b16 v[168:169], v18 offset:4096
  ds_read_b64_tr_b16 v[172:173], v19 offset:4096
  ds_read_b64_tr_b16 v[176:177], v20 offset:4096
  ds_read_b64_tr_b16 v[180:181], v21 offset:4096
  ds_read_b64_tr_b16 v[170:171], v18 offset:6144
  ds_read_b64_tr_b16 v[174:175], v19 offset:6144
  ds_read_b64_tr_b16 v[178:179], v20 offset:6144
  ds_read_b64_tr_b16 v[182:183], v21 offset:6144
  ds_read_b128 v[212:215], v22 offset:0
  ds_read_b128 v[216:219], v22 offset:2048
  ds_read_b128 v[220:223], v22 offset:4096
  v_mfma_f32_16x16x32_bf16 v[40:43], v[136:139], v[200:203], v[40:43]
  v_mfma_f32_16x16x32_bf16 v[44:47], v[136:139], v[204:207], v[44:47]
  v_mfma_f32_16x16x32_bf16 v[48:51], v[136:139], v[208:211], v[48:51]
  v_mfma_f32_16x16x32_bf16 v[52:55], v[140:143], v[200:203], v[52:55]
  v_mfma_f32_16x16x32_bf16 v[56:59], v[140:143], v[204:207], v[56:59]
  v_mfma_f32_16x16x32_bf16 v[60:63], v[140:143], v[208:211], v[60:63]
  s_waitcnt lgkmcnt(0)
  s_mul_i32 s77, s70, 262144
  s_add_u32 s77, s77, s69
  s_add_u32 m0, s73, 4096
  s_nop 0
  buffer_load_dwordx4 v10, s[24:27], s77 offen lds
  buffer_load_dwordx4 v11, s[24:27], s77 offen offset:1024 lds
  buffer_load_dwordx4 v12, s[24:27], s77 offen offset:2048 lds
  buffer_load_dwordx4 v13, s[24:27], s77 offen offset:3072 lds
  s_add_u32 s70, s70, 1
  s_and_b32 s70, s70, 15
  v_mfma_f32_16x16x32_bf16 v[64:67], v[144:147], v[200:203], v[64:67]
  v_mfma_f32_16x16x32_bf16 v[68:71], v[144:147], v[204:207], v[68:71]
  v_mfma_f32_16x16x32_bf16 v[72:75], v[144:147], v[208:211], v[72:75]
  v_mfma_f32_16x16x32_bf16 v[76:79], v[148:151], v[200:203], v[76:79]
  v_mfma_f32_16x16x32_bf16 v[80:83], v[148:151], v[204:207], v[80:83]
  v_mfma_f32_16x16x32_bf16 v[84:87], v[148:151], v[208:211], v[84:87]
  s_sub_u32 s72, s72, 1
  s_cmp_lg_u32 s72, 0
  s_cbranch_scc1 L_qb_25
  s_and_b32 s74, s71, 1
  s_lshl_b32 s74, s74, 6
  s_lshr_b32 s75, s71, 1
  v_xor_b32 v22, s74, v23
  s_mul_i32 s75, s75, 6144
  v_add_u32 v22, s75, v22
  s_add_u32 s71, s71, 1
  s_and_b32 s71, s71, 15
  s_waitcnt vmcnt(4)
  ds_read_b64_tr_b16 v[136:137], v18 offset:0
  ds_read_b64_tr_b16 v[140:141], v19 offset:0
  ds_read_b64_tr_b16 v[144:145], v20 offset:0
  ds_read_b64_tr_b16 v[148:149], v21 offset:0
  ds_read_b64_tr_b16 v[138:139], v18 offset:2048
  ds_read_b64_tr_b16 v[142:143], v19 offset:2048
  ds_read_b64_tr_b16 v[146:147], v20 offset:2048
  ds_read_b64_tr_b16 v[150:151], v21 offset:2048
  ds_read_b128 v[200:203], v22 offset:0
  ds_read_b128 v[204:207], v22 offset:2048
  ds_read_b128 v[208:211], v22 offset:4096
  v_mfma_f32_16x16x32_bf16 v[40:43], v[168:171], v[212:215], v[40:43]
  v_mfma_f32_16x16x32_bf16 v[44:47], v[168:171], v[216:219], v[44:47]
  v_mfma_f32_16x16x32_bf16 v[48:51], v[168:171], v[220:223], v[48:51]
  v_mfma_f32_16x16x32_bf16 v[52:55], v[172:175], v[212:215], v[52:55]
  v_mfma_f32_16x16x32_bf16 v[56:59], v[172:175], v[216:219], v[56:59]
  v_mfma_f32_16x16x32_bf16 v[60:63], v[172:175], v[220:223], v[60:63]
  s_waitcnt lgkmcnt(0)
  s_mul_i32 s77, s70, 262144
  s_add_u32 s77, s77, s69
  s_mov_b32 m0, s73
  s_nop 0
  buffer_load_dwordx4 v10, s[24:27], s77 offen lds
  buffer_load_dwordx4 v11, s[24:27], s77 offen offset:1024 lds
  buffer_load_dwordx4 v12, s[24:27], s77 offen offset:2048 lds
  buffer_load_dwordx4 v13, s[24:27], s77 offen offset:3072 lds
  s_add_u32 s70, s70, 1
  s_and_b32 s70, s70, 15
  v_mfma_f32_16x16x32_bf16 v[64:67], v[176:179], v[212:215], v[64:67]
  v_mfma_f32_16x16x32_bf16 v[68:71], v[176:179], v[216:219], v[68:71]
  v_mfma_f32_16x16x32_bf16 v[72:75], v[176:179], v[220:223], v[72:75]
  v_mfma_f32_16x16x32_bf16 v[76:79], v[180:183], v[212:215], v[76:79]
  v_mfma_f32_16x16x32_bf16 v[80:83], v[180:183], v[216:219], v[80:83]
  v_mfma_f32_16x16x32_bf16 v[84:87], v[180:183], v[220:223], v[84:87]
  s_and_b32 s74, s71, 1
  s_lshl_b32 s74, s74, 6
  s_lshr_b32 s75, s71, 1
  v_xor_b32 v22, s74, v23
  s_mul_i32 s75, s75, 6144
  v_add_u32 v22, s75, v22
  s_add_u32 s71, s71, 1
  s_and_b32 s71, s71, 15
  s_waitcnt vmcnt(4)
  ds_read_b64_tr_b16 v[168:169], v18 offset:4096
  ds_read_b64_tr_b16 v[172:173], v19 offset:4096
  ds_read_b64_tr_b16 v[176:177], v20 offset:4096
  ds_read_b64_tr_b16 v[180:181], v21 offset:4096
  ds_read_b64_tr_b16 v[170:171], v18 offset:6144
  ds_read_b64_tr_b16 v[174:175], v19 offset:6144
  ds_read_b64_tr_b16 v[178:179], v20 offset:6144
  ds_read_b64_tr_b16 v[182:183], v21 offset:6144
  ds_read_b128 v[212:215], v22 offset:0
  ds_read_b128 v[216:219], v22 offset:2048
  ds_read_b128 v[220:223], v22 offset:4096
  v_mfma_f32_16x16x32_bf16 v[40:43], v[136:139], v[200:203], v[40:43]
  v_mfma_f32_16x16x32_bf16 v[44:47], v[136:139], v[204:207], v[44:47]
  v_mfma_f32_16x16x32_bf16 v[48:51], v[136:139], v[208:211], v[48:51]
  v_mfma_f32_16x16x32_bf16 v[52:55], v[140:143], v[200:203], v[52:55]
  v_mfma_f32_16x16x32_bf16 v[56:59], v[140:143], v[204:207], v[56:59]
  v_mfma_f32_16x16x32_bf16 v[60:63], v[140:143], v[208:211], v[60:63]
  s_waitcnt lgkmcnt(0)
  s_mul_i32 s77, s70, 262144
  s_add_u32 s77, s77, s69
  s_add_u32 m0, s73, 4096
  s_nop 0
  buffer_load_dwordx4 v10, s[24:27], s77 offen lds
  buffer_load_dwordx4 v11, s[24:27], s77 offen offset:1024 lds
  buffer_load_dwordx4 v12, s[24:27], s77 offen offset:2048 lds
  buffer_load_dwordx4 v13, s[24:27], s77 offen offset:3072 lds
  s_add_u32 s70, s70, 1
  s_and_b32 s70, s70, 15
  v_mfma_f32_16x16x32_bf16 v[64:67], v[144:147], v[200:203], v[64:67]
  v_mfma_f32_16x16x32_bf16 v[68:71], v[144:147], v[204:207], v[68:71]
  v_mfma_f32_16x16x32_bf16 v[72:75], v[144:147], v[208:211], v[72:75]
  v_mfma_f32_16x16x32_bf16 v[76:79], v[148:151], v[200:203], v[76:79]
  v_mfma_f32_16x16x32_bf16 v[80:83], v[148:151], v[204:207], v[80:83]
  v_mfma_f32_16x16x32_bf16 v[84:87], v[148:151], v[208:211], v[84:87]
  s_and_b32 s74, s71, 1
  s_lshl_b32 s74, s74, 6
  s_lshr_b32 s75, s71, 1
  v_xor_b32 v22, s74, v23
  s_mul_i32 s75, s75, 6144
  v_add_u32 v22, s75, v22
  s_add_u32 s71, s71, 1
  s_and_b32 s71, s71, 15
  s_waitcnt vmcnt(4)
  ds_read_b64_tr_b16 v[136:137], v18 offset:0
  ds_read_b64_tr_b16 v[140:141], v19 offset:0
  ds_read_b64_tr_b16 v[144:145], v20 offset:0
  ds_read_b64_tr_b16 v[148:149], v21 offset:0
  ds_read_b64_tr_b16 v[138:139], v18 offset:2048
  ds_read_b64_tr_b16 v[142:143], v19 offset:2048
  ds_read_b64_tr_b16 v[146:147], v20 offset:2048
  ds_read_b64_tr_b16 v[150:151], v21 offset:2048
  ds_read_b128 v[200:203], v22 offset:0
  ds_read_b128 v[204:207], v22 offset:2048
  ds_read_b128 v[208:211], v22 offset:4096
  v_mfma_f32_16x16x32_bf16 v[40:43], v[168:171], v[212:215], v[40:43]
  v_mfma_f32_16x16x32_bf16 v[44:47], v[168:171], v[216:219], v[44:47]
  v_mfma_f32_16x16x32_bf16 v[48:51], v[168:171], v[220:223], v[48:51]
  v_mfma_f32_16x16x32_bf16 v[52:55], v[172:175], v[212:215], v[52:55]
  v_mfma_f32_16x16x32_bf16 v[56:59], v[172:175], v[216:219], v[56:59]
  v_mfma_f32_16x16x32_bf16 v[60:63], v[172:175], v[220:223], v[60:63]
  s_waitcnt lgkmcnt(0)
  v_mfma_f32_16x16x32_bf16 v[64:67], v[176:179], v[212:215], v[64:67]
  v_mfma_f32_16x16x32_bf16 v[68:71], v[176:179], v[216:219], v[68:71]
  v_mfma_f32_16x16x32_bf16 v[72:75], v[176:179], v[220:223], v[72:75]
  v_mfma_f32_16x16x32_bf16 v[76:79], v[180:183], v[212:215], v[76:79]
  v_mfma_f32_16x16x32_bf16 v[80:83], v[180:183], v[216:219], v[80:83]
  v_mfma_f32_16x16x32_bf16 v[84:87], v[180:183], v[220:223], v[84:87]
  s_and_b32 s74, s71, 1
  s_lshl_b32 s74, s74, 6
  s_lshr_b32 s75, s71, 1
  v_xor_b32 v22, s74, v23
  s_mul_i32 s75, s75, 6144
  v_add_u32 v22, s75, v22
  s_add_u32 s71, s71, 1
  s_and_b32 s71, s71, 15
  s_waitcnt vmcnt(0)
  ds_read_b64_tr_b16 v[168:169], v18 offset:4096
  ds_read_b64_tr_b16 v[172:173], v19 offset:4096
  ds_read_b64_tr_b16 v[176:177], v20 offset:4096
  ds_read_b64_tr_b16 v[180:181], v21 offset:4096
  ds_read_b64_tr_b16 v[170:171], v18 offset:6144
  ds_read_b64_tr_b16 v[174:175], v19 offset:6144
  ds_read_b64_tr_b16 v[178:179], v20 offset:6144
  ds_read_b64_tr_b16 v[182:183], v21 offset:6144
  ds_read_b128 v[212:215], v22 offset:0
  ds_read_b128 v[216:219], v22 offset:2048
  ds_read_b128 v[220:223], v22 offset:4096
  v_mfma_f32_16x16x32_bf16 v[40:43], v[136:139], v[200:203], v[40:43]
  v_mfma_f32_16x16x32_bf16 v[44:47], v[136:139], v[204:207], v[44:47]
  v_mfma_f32_16x16x32_bf16 v[48:51], v[136:139], v[208:211], v[48:51]
  v_mfma_f32_16x16x32_bf16 v[52:55], v[140:143], v[200:203], v[52:55]
  v_mfma_f32_16x16x32_bf16 v[56:59], v[140:143], v[204:207], v[56:59]
  v_mfma_f32_16x16x32_bf16 v[60:63], v[140:143], v[208:211], v[60:63]
  s_waitcnt lgkmcnt(0)
  v_mfma_f32_16x16x32_bf16 v[64:67], v[144:147], v[200:203], v[64:67]
  v_mfma_f32_16x16x32_bf16 v[68:71], v[144:147], v[204:207], v[68:71]
  v_mfma_f32_16x16x32_bf16 v[72:75], v[144:147], v[208:211], v[72:75]
  v_mfma_f32_16x16x32_bf16 v[76:79], v[148:151], v[200:203], v[76:79]
  v_mfma_f32_16x16x32_bf16 v[80:83], v[148:151], v[204:207], v[80:83]
  v_mfma_f32_16x16x32_bf16 v[84:87], v[148:151], v[208:211], v[84:87]
  v_mfma_f32_16x16x32_bf16 v[40:43], v[168:171], v[212:215], v[40:43]
  v_mfma_f32_16x16x32_bf16 v[44:47], v[168:171], v[216:219], v[44:47]
  v_mfma_f32_16x16x32_bf16 v[48:51], v[168:171], v[220:223], v[48:51]
  v_mfma_f32_16x16x32_bf16 v[52:55], v[172:175], v[212:215], v[52:55]
  v_mfma_f32_16x16x32_bf16 v[56:59], v[172:175], v[216:219], v[56:59]
  v_mfma_f32_16x16x32_bf16 v[60:63], v[172:175], v[220:223], v[60:63]
  v_mfma_f32_16x16x32_bf16 v[64:67], v[176:179], v[212:215], v[64:67]
  v_mfma_f32_16x16x32_bf16 v[68:71], v[176:179], v[216:219], v[68:71]
  v_mfma_f32_16x16x32_bf16 v[72:75], v[176:179], v[220:223], v[72:75]
  v_mfma_f32_16x16x32_bf16 v[76:79], v[180:183], v[212:215], v[76:79]
  v_mfma_f32_16x16x32_bf16 v[80:83], v[180:183], v[216:219], v[80:83]
  v_mfma_f32_16x16x32_bf16 v[84:87], v[180:183], v[220:223], v[84:87]
  s_nop 7
  v_cvt_pk_bf16_f32 v136, v40, v41
  v_cvt_pk_bf16_f32 v137, v42, v43
  v_cvt_pk_bf16_f32 v138, v52, v53
  v_cvt_pk_bf16_f32 v139, v54, v55
  v_cvt_pk_bf16_f32 v140, v44, v45
  v_cvt_pk_bf16_f32 v141, v46, v47
  v_cvt_pk_bf16_f32 v142, v56, v57
  v_cvt_pk_bf16_f32 v143, v58, v59
  v_cvt_pk_bf16_f32 v144, v48, v49
  v_cvt_pk_bf16_f32 v145, v50, v51
  v_cvt_pk_bf16_f32 v146, v60, v61
  v_cvt_pk_bf16_f32 v147, v62, v63
  v_cvt_pk_bf16_f32 v148, v64, v65
  v_cvt_pk_bf16_f32 v149, v66, v67
  v_cvt_pk_bf16_f32 v150, v76, v77
  v_cvt_pk_bf16_f32 v151, v78, v79
  v_cvt_pk_bf16_f32 v152, v68, v69
  v_cvt_pk_bf16_f32 v153, v70, v71
  v_cvt_pk_bf16_f32 v154, v80, v81
  v_cvt_pk_bf16_f32 v155, v82, v83
  v_cvt_pk_bf16_f32 v156, v72, v73
  v_cvt_pk_bf16_f32 v157, v74, v75
  v_cvt_pk_bf16_f32 v158, v84, v85
  v_cvt_pk_bf16_f32 v159, v86, v87
  s_nop 1
  v_permlane16_swap_b32 v136, v138
  v_permlane16_swap_b32 v137, v139
  v_permlane16_swap_b32 v140, v142
  v_permlane16_swap_b32 v141, v143
  v_permlane16_swap_b32 v144, v146
  v_permlane16_swap_b32 v145, v147
  v_permlane16_swap_b32 v148, v150
  v_permlane16_swap_b32 v149, v151
  v_permlane16_swap_b32 v152, v154
  v_permlane16_swap_b32 v153, v155
  v_permlane16_swap_b32 v156, v158
  v_permlane16_swap_b32 v157, v159
  s_setprio 0
  s_mov_b64 exec, 1
  ds_add_u32 v24, v25 offset:0
  s_mov_b64 exec, -1
  v_lshlrev_b32 v37, 4, v1
  v_add_u32 v22, s73, v37
  ds_write_b128 v22, v[136:139] offset:0
  ds_write_b128 v22, v[140:143] offset:1024
  ds_write_b128 v22, v[144:147] offset:2048
  ds_write_b128 v22, v[148:151] offset:3072
  ds_write_b128 v22, v[152:155] offset:4096
  ds_write_b128 v22, v[156:159] offset:5120
  s_waitcnt lgkmcnt(0)
  s_mov_b64 exec, 1
  ds_add_u32 v0, v25 offset:48
  s_mov_b64 exec, -1
  v_lshrrev_b32 v2, 2, v1
  v_and_b32 v3, 3, v1
  v_and_b32 v4, 7, v2
  v_lshlrev_b32 v3, 3, v3
  v_lshl_add_u32 v3, v4, 5, v3
  v_lshl_add_u32 v3, v2, 8, v3
  v_add_u32 v18, s73, v3
  v_xor_b32 v4, 32, v3
  v_add_u32 v19, s73, v4
  v_xor_b32 v4, 64, v3
  v_add_u32 v20, s73, v4
  v_xor_b32 v4, 96, v3
  v_add_u32 v21, s73, v4
  v_xor_b32 v4, 128, v3
  v_add_u32 v6, s73, v4
  v_xor_b32 v4, 160, v3
  v_add_u32 v7, s73, v4
  v_xor_b32 v4, 192, v3
  v_add_u32 v38, s73, v4
  v_xor_b32 v4, 224, v3
  v_add_u32 v39, s73, v4
  v_lshrrev_b32 v2, 4, v1
  v_lshlrev_b32 v2, 13, v2
  v_and_b32 v3, 0xff, v8
  v_add_u32 v10, v2, v3
  v_and_b32 v3, 0xff, v9
  v_add_u32 v3, 64512, v3
  v_add_u32 v11, v2, v3
  v_and_b32 v3, 0xff, v8
  v_add_u32 v3, 129024, v3
  v_add_u32 v12, v2, v3
  v_and_b32 v3, 0xff, v9
  v_add_u32 v3, 193536, v3
  v_add_u32 v13, v2, v3
  s_mov_b32 s12, s40
  s_mov_b32 s13, s41
  s_mov_b32 s14, 1572864
  s_mov_b32 s15, 0x20000
  s_mov_b32 s24, s46
  s_mov_b32 s25, s47
  s_mov_b32 s26, 4194304
  s_mov_b32 s27, 0x20000
  s_cmp_lt_u32 s4, 2
  s_cselect_b32 s16, s42, s44
  s_cselect_b32 s17, s43, s45
  s_mov_b32 s18, 33554432
  s_mov_b32 s19, 0x20000
  s_lshl_b32 s83, s5, 3
  s_add_u32 s83, s83, s6
  s_lshl_b32 s83, s83, 17
  s_lshr_b32 s81, s83, 17
  s_add_u32 s81, s81, s5
  s_and_b32 s81, s81, 15
  s_and_b32 s74, s4, 1
  s_lshl_b32 s74, s74, 12
  s_add_u32 s83, s83, s74
  s_lshl_b32 s69, s6, 2
  s_add_u32 s69, s69, s4
  s_lshl_b32 s69, s69, 8
  s_lshr_b32 s70, s5, 2
  s_lshl_b32 s70, s70, 1
  s_mov_b32 s71, s70
  s_or_b32 s74, s4, s6
  s_cmp_lg_u32 s74, 0
  s_cbranch_scc1 L_noinit_26
  s_mov_b64 exec, 1
  v_mov_b32 v4, 0
  s_mov_b32 s79, 0
  s_lshl_b32 s75, s79, 5
  s_add_u32 s75, s75, s5
  s_lshl_b32 s75, s75, 8
  s_add_u32 s75, s75, 33554432
  v_mov_b32 v3, s75
  buffer_store_dword v4, v3, s[28:31], 0 offen sc1
  s_mov_b32 s79, 1
  s_lshl_b32 s75, s79, 5
  s_add_u32 s75, s75, s5
  s_lshl_b32 s75, s75, 8
  s_add_u32 s75, s75, 33554432
  v_mov_b32 v5, s75
  buffer_store_dword v4, v5, s[28:31], 0 offen sc1
  s_lshl_b32 s75, s5, 2
  v_mov_b32 v3, s75
  s_waitcnt vmcnt(0)
  buffer_atomic_add v25, v3, s[36:39], 0 offen
  s_mov_b64 exec, -1
L_noinit_26:
L_spin_27:
  ds_read_b32 v2, v24 offset:0
  s_waitcnt lgkmcnt(0)
  v_readfirstlane_b32 s74, v2
  s_nop 0
  s_cmp_ge_u32 s74, 8
  s_cbranch_scc1 L_spun_28
  s_sleep 1
  s_branch L_spin_27
L_spun_28:
  s_bitcmp1_b32 s5, 2
  s_mov_b32 s75, 0x23180c00
  s_cselect_b32 s75, s75, 0x23180c00
  s_and_b32 s80, s5, 3
  s_lshl_b32 s80, s80, 3
  s_lshr_b32 s80, s75, s80
  s_and_b32 s80, s80, 0xff
  s_cbranch_scc1 L_e0_29
  s_mov_b64 exec, 1
  ds_add_u32 v24, v25 offset:64
  s_mov_b64 exec, -1
L_e0_29:
  s_bitcmp1_b32 s5, 2
  s_mov_b32 s75, 0x1d120600
  s_cselect_b32 s75, s75, 0x1d120600
  s_and_b32 s80, s5, 3
  s_lshl_b32 s80, s80, 3
  s_lshr_b32 s80, s75, s80
  s_and_b32 s80, s80, 0xff
L_spin_30:
  ds_read_b32 v2, v24 offset:68
  s_waitcnt lgkmcnt(0)
  v_readfirstlane_b32 s74, v2
  s_nop 0
  s_cmp_ge_u32 s74, s80
  s_cbranch_scc1 L_spun_31
  s_sleep 8
  s_branch L_spin_30
L_spun_31:
  s_setprio 3
  v_lshrrev_b32 v2, 4, v1
  v_and_b32 v4, 7, v1
  v_xor_b32 v4, v4, v2
  v_lshrrev_b32 v36, 3, v1
  v_lshlrev_b32 v36, 10, v36
  v_lshl_add_u32 v36, v4, 4, v36
  s_mul_i32 s74, s5, 49152
  s_mul_i32 s75, s4, 256
  s_add_u32 s74, s74, s75
  s_mul_i32 s75, s4, 12288
  s_add_u32 s75, s75, 32768
  v_xor_b32 v5, 64, v36
  s_add_u32 m0, s75, 0
  s_add_u32 s77, s74, 0
  buffer_load_dwordx4 v36, s[12:15], s77 offen lds
  s_add_u32 m0, s75, 1024
  s_add_u32 s77, s74, 8192
  buffer_load_dwordx4 v5, s[12:15], s77 offen lds
  s_add_u32 m0, s75, 2048
  s_add_u32 s77, s74, 16384
  buffer_load_dwordx4 v36, s[12:15], s77 offen lds
  s_add_u32 m0, s75, 3072
  s_add_u32 s77, s74, 24576
  buffer_load_dwordx4 v5, s[12:15], s77 offen lds
  s_add_u32 m0, s75, 4096
  s_add_u32 s77, s74, 32768
  buffer_load_dwordx4 v36, s[12:15], s77 offen lds
  s_add_u32 m0, s75, 5120
  s_add_u32 s77, s74, 40960
  buffer_load_dwordx4 v5, s[12:15], s77 offen lds
  s_add_u32 m0, s75, 6144
  s_add_u32 s77, s74, 128
  buffer_load_dwordx4 v36, s[12:15], s77 offen lds
  s_add_u32 m0, s75, 7168
  s_add_u32 s77, s74, 8320
  buffer_load_dwordx4 v5, s[12:15], s77 offen lds
  s_add_u32 m0, s75, 8192
  s_add_u32 s77, s74, 16512
  buffer_load_dwordx4 v36, s[12:15], s77 offen lds
  s_add_u32 m0, s75, 9216
  s_add_u32 s77, s74, 24704
  buffer_load_dwordx4 v5, s[12:15], s77 offen lds
  s_add_u32 m0, s75, 10240
  s_add_u32 s77, s74, 32896
  buffer_load_dwordx4 v36, s[12:15], s77 offen lds
  s_add_u32 m0, s75, 11264
  s_add_u32 s77, s74, 41088
  buffer_load_dwordx4 v5, s[12:15], s77 offen lds
L_spin_32:
  ds_read_b32 v2, v0 offset:32
  s_waitcnt lgkmcnt(0)
  v_readfirstlane_b32 s74, v2
  s_nop 0
  s_cmp_ge_u32 s74, 1
  s_cbranch_scc1 L_spun_33
  s_sleep 1
  s_branch L_spin_32
L_spun_33:
  s_mul_i32 s77, s70, 262144
  s_add_u32 s77, s77, s69
  s_add_u32 s70, s70, 1
  s_and_b32 s70, s70, 15
  s_mov_b32 m0, s73
  s_nop 0
  buffer_load_dwordx4 v10, s[24:27], s77 offen lds
  buffer_load_dwordx4 v11, s[24:27], s77 offen offset:1024 lds
  buffer_load_dwordx4 v12, s[24:27], s77 offen offset:2048 lds
  buffer_load_dwordx4 v13, s[24:27], s77 offen offset:3072 lds
  s_add_u32 s77, s77, 32768
  s_add_u32 m0, s73, 4096
  s_nop 0
  buffer_load_dwordx4 v10, s[24:27], s77 offen lds
  buffer_load_dwordx4 v11, s[24:27], s77 offen offset:1024 lds
  buffer_load_dwordx4 v12, s[24:27], s77 offen offset:2048 lds
  buffer_load_dwordx4 v13, s[24:27], s77 offen offset:3072 lds
  s_setprio 0
  s_waitcnt vmcnt(8)
  s_waitcnt lgkmcnt(0)
  s_mov_b64 exec, 1
  ds_add_u32 v24, v25 offset:4
  s_mov_b64 exec, -1
  s_bitcmp1_b32 s5, 2
  s_mov_b32 s75, 0x23180c00
  s_cselect_b32 s75, s75, 0x23180c00
  s_and_b32 s80, s5, 3
  s_lshl_b32 s80, s80, 3
  s_lshr_b32 s80, s75, s80
  s_and_b32 s80, s80, 0xff
L_spin_34:
  ds_read_b32 v2, v24 offset:68
  s_waitcnt lgkmcnt(0)
  v_readfirstlane_b32 s74, v2
  s_nop 0
  s_cmp_ge_u32 s74, s80
  s_cbranch_scc1 L_spun_35
  s_sleep 8
  s_branch L_spin_34
L_spun_35:
  s_bitcmp1_b32 s5, 2
  s_mov_b32 s75, 0x23180c00
  s_cselect_b32 s75, s75, 0x23180c00
  s_and_b32 s80, s5, 3
  s_lshl_b32 s80, s80, 3
  s_lshr_b32 s80, s75, s80
  s_and_b32 s80, s80, 0xff
  s_cbranch_scc0 L_e0_36
  s_mov_b64 exec, 1
  ds_add_u32 v24, v25 offset:64
  s_mov_b64 exec, -1
L_e0_36:
L_spin_37:
  ds_read_b32 v2, v24 offset:4
  s_waitcnt lgkmcnt(0)
  v_readfirstlane_b32 s74, v2
  s_nop 0
  s_cmp_ge_u32 s74, 4
  s_cbranch_scc1 L_spun_38
  s_sleep 1
  s_branch L_spin_37
L_spun_38:
  s_mul_i32 s68, s4, 12288
  s_add_u32 s68, s68, 32768
  v_mov_b32 v40, 0
  v_mov_b32 v41, 0
  v_mov_b32 v42, 0
  v_mov_b32 v43, 0
  v_mov_b32 v44, 0
  v_mov_b32 v45, 0
  v_mov_b32 v46, 0
  v_mov_b32 v47, 0
  v_mov_b32 v48, 0
  v_mov_b32 v49, 0
  v_mov_b32 v50, 0
  v_mov_b32 v51, 0
  v_mov_b32 v52, 0
  v_mov_b32 v53, 0
  v_mov_b32 v54, 0
  v_mov_b32 v55, 0
  v_mov_b32 v56, 0
  v_mov_b32 v57, 0
  v_mov_b32 v58, 0
  v_mov_b32 v59, 0
  v_mov_b32 v60, 0
  v_mov_b32 v61, 0
  v_mov_b32 v62, 0
  v_mov_b32 v63, 0
  v_mov_b32 v64, 0
  v_mov_b32 v65, 0
  v_mov_b32 v66, 0
  v_mov_b32 v67, 0
  v_mov_b32 v68, 0
  v_mov_b32 v69, 0
  v_mov_b32 v70, 0
  v_mov_b32 v71, 0
  v_mov_b32 v72, 0
  v_mov_b32 v73, 0
  v_mov_b32 v74, 0
  v_mov_b32 v75, 0
  v_mov_b32 v76, 0
  v_mov_b32 v77, 0
  v_mov_b32 v78, 0
  v_mov_b32 v79, 0
  v_mov_b32 v80, 0
  v_mov_b32 v81, 0
  v_mov_b32 v82, 0
  v_mov_b32 v83, 0
  v_mov_b32 v84, 0
  v_mov_b32 v85, 0
  v_mov_b32 v86, 0
  v_mov_b32 v87, 0
  v_mov_b32 v88, 0
  v_mov_b32 v89, 0
  v_mov_b32 v90, 0
  v_mov_b32 v91, 0
  v_mov_b32 v92, 0
  v_mov_b32 v93, 0
  v_mov_b32 v94, 0
  v_mov_b32 v95, 0
  v_mov_b32 v96, 0
  v_mov_b32 v97, 0
  v_mov_b32 v98, 0
  v_mov_b32 v99, 0
  v_mov_b32 v100, 0
  v_mov_b32 v101, 0
  v_mov_b32 v102, 0
  v_mov_b32 v103, 0
  v_mov_b32 v104, 0
  v_mov_b32 v105, 0
  v_mov_b32 v106, 0
  v_mov_b32 v107, 0
  v_mov_b32 v108, 0
  v_mov_b32 v109, 0
  v_mov_b32 v110, 0
  v_mov_b32 v111, 0
  v_mov_b32 v112, 0
  v_mov_b32 v113, 0
  v_mov_b32 v114, 0
  v_mov_b32 v115, 0
  v_mov_b32 v116, 0
  v_mov_b32 v117, 0
  v_mov_b32 v118, 0
  v_mov_b32 v119, 0
  v_mov_b32 v120, 0
  v_mov_b32 v121, 0
  v_mov_b32 v122, 0
  v_mov_b32 v123, 0
  v_mov_b32 v124, 0
  v_mov_b32 v125, 0
  v_mov_b32 v126, 0
  v_mov_b32 v127, 0
  v_mov_b32 v128, 0
  v_mov_b32 v129, 0
  v_mov_b32 v130, 0
  v_mov_b32 v131, 0
  v_mov_b32 v132, 0
  v_mov_b32 v133, 0
  v_mov_b32 v134, 0
  v_mov_b32 v135, 0
  s_and_b32 s74, s71, 1
  s_lshl_b32 s74, s74, 6
  s_lshr_b32 s75, s71, 1
  v_xor_b32 v22, s74, v23
  s_mul_i32 s75, s75, 6144
  v_add_u32 v22, s75, v22
  s_add_u32 s71, s71, 1
  s_and_b32 s71, s71, 15
  s_waitcnt vmcnt(4)
  ds_read_b64_tr_b16 v[136:137], v18
  ds_read_b64_tr_b16 v[140:141], v19
  ds_read_b64_tr_b16 v[144:145], v20
  ds_read_b64_tr_b16 v[148:149], v21
  ds_read_b64_tr_b16 v[152:153], v6
  ds_read_b64_tr_b16 v[156:157], v7
  ds_read_b64_tr_b16 v[160:161], v38
  ds_read_b64_tr_b16 v[164:165], v39
  s_waitcnt lgkmcnt(0)
  s_mul_i32 s77, s70, 262144
  s_add_u32 s77, s77, s69
  s_add_u32 s70, s70, 1
  s_and_b32 s70, s70, 15
  s_mov_b32 m0, s73
  s_nop 0
  buffer_load_dwordx4 v10, s[24:27], s77 offen lds
  buffer_load_dwordx4 v11, s[24:27], s77 offen offset:1024 lds
  buffer_load_dwordx4 v12, s[24:27], s77 offen offset:2048 lds
  buffer_load_dwordx4 v13, s[24:27], s77 offen offset:3072 lds
  s_waitcnt vmcnt(4)
  ds_read_b64_tr_b16 v[138:139], v18 offset:4096
  ds_read_b64_tr_b16 v[142:143], v19 offset:4096
  ds_read_b64_tr_b16 v[146:147], v20 offset:4096
  ds_read_b64_tr_b16 v[150:151], v21 offset:4096
  ds_read_b64_tr_b16 v[154:155], v6 offset:4096
  ds_read_b64_tr_b16 v[158:159], v7 offset:4096
  ds_read_b64_tr_b16 v[162:163], v38 offset:4096
  ds_read_b64_tr_b16 v[166:167], v39 offset:4096
  ds_read_b128 v[200:203], v22 offset:0
  ds_read_b128 v[204:207], v22 offset:2048
  ds_read_b128 v[208:211], v22 offset:4096
  s_waitcnt lgkmcnt(0)
  s_add_u32 s77, s77, 32768
  s_add_u32 m0, s73, 4096
  s_nop 0
  buffer_load_dwordx4 v10, s[24:27], s77 offen lds
  buffer_load_dwordx4 v11, s[24:27], s77 offen offset:1024 lds
  buffer_load_dwordx4 v12, s[24:27], s77 offen offset:2048 lds
  buffer_load_dwordx4 v13, s[24:27], s77 offen offset:3072 lds
  s_and_b32 s74, s71, 1
  s_lshl_b32 s74, s74, 6
  s_lshr_b32 s75, s71, 1
  v_xor_b32 v22, s74, v23
  s_mul_i32 s75, s75, 6144
  v_add_u32 v22, s75, v22
  s_add_u32 s71, s71, 1
  s_and_b32 s71, s71, 15
  s_waitcnt vmcnt(4)
  ds_read_b64_tr_b16 v[168:169], v18
  ds_read_b64_tr_b16 v[172:173], v19
  ds_read_b64_tr_b16 v[176:177], v20
  ds_read_b64_tr_b16 v[180:181], v21
  ds_read_b64_tr_b16 v[184:185], v6
  ds_read_b64_tr_b16 v[188:189], v7
  ds_read_b64_tr_b16 v[192:193], v38
  ds_read_b64_tr_b16 v[196:197], v39
  v_mfma_f32_16x16x32_bf16 v[40:43], v[136:139], v[200:203], v[40:43]
  v_mfma_f32_16x16x32_bf16 v[44:47], v[136:139], v[204:207], v[44:47]
  v_mfma_f32_16x16x32_bf16 v[48:51], v[136:139], v[208:211], v[48:51]
  v_mfma_f32_16x16x32_bf16 v[52:55], v[140:143], v[200:203], v[52:55]
  v_mfma_f32_16x16x32_bf16 v[56:59], v[140:143], v[204:207], v[56:59]
  v_mfma_f32_16x16x32_bf16 v[60:63], v[140:143], v[208:211], v[60:63]
  v_mfma_f32_16x16x32_bf16 v[64:67], v[144:147], v[200:203], v[64:67]
  s_waitcnt lgkmcnt(0)
  s_mul_i32 s77, s70, 262144
  s_add_u32 s77, s77, s69
  s_add_u32 s70, s70, 1
  s_and_b32 s70, s70, 15
  s_mov_b32 m0, s73
  s_nop 0
  buffer_load_dwordx4 v10, s[24:27], s77 offen lds
  buffer_load_dwordx4 v11, s[24:27], s77 offen offset:1024 lds
  buffer_load_dwordx4 v12, s[24:27], s77 offen offset:2048 lds
  buffer_load_dwordx4 v13, s[24:27], s77 offen offset:3072 lds
  s_waitcnt vmcnt(4)
  ds_read_b64_tr_b16 v[170:171], v18 offset:4096
  ds_read_b64_tr_b16 v[174:175], v19 offset:4096
  ds_read_b64_tr_b16 v[178:179], v20 offset:4096
  ds_read_b64_tr_b16 v[182:183], v21 offset:4096
  ds_read_b64_tr_b16 v[186:187], v6 offset:4096
  ds_read_b64_tr_b16 v[190:191], v7 offset:4096
  ds_read_b64_tr_b16 v[194:195], v38 offset:4096
  ds_read_b64_tr_b16 v[198:199], v39 offset:4096
  ds_read_b128 v[212:215], v22 offset:0
  ds_read_b128 v[216:219], v22 offset:2048
  ds_read_b128 v[220:223], v22 offset:4096
  v_mfma_f32_16x16x32_bf16 v[68:71], v[144:147], v[204:207], v[68:71]
  v_mfma_f32_16x16x32_bf16 v[72:75], v[144:147], v[208:211], v[72:75]
  v_mfma_f32_16x16x32_bf16 v[76:79], v[148:151], v[200:203], v[76:79]
  v_mfma_f32_16x16x32_bf16 v[80:83], v[148:151], v[204:207], v[80:83]
  v_mfma_f32_16x16x32_bf16 v[84:87], v[148:151], v[208:211], v[84:87]
  v_mfma_f32_16x16x32_bf16 v[88:91], v[152:155], v[200:203], v[88:91]
  v_mfma_f32_16x16x32_bf16 v[92:95], v[152:155], v[204:207], v[92:95]
  v_mfma_f32_16x16x32_bf16 v[96:99], v[152:155], v[208:211], v[96:99]
  v_mfma_f32_16x16x32_bf16 v[100:103], v[156:159], v[200:203], v[100:103]
  s_waitcnt lgkmcnt(0)
  s_add_u32 s77, s77, 32768
  s_add_u32 m0, s73, 4096
  s_nop 0
  buffer_load_dwordx4 v10, s[24:27], s77 offen lds
  buffer_load_dwordx4 v11, s[24:27], s77 offen offset:1024 lds
  buffer_load_dwordx4 v12, s[24:27], s77 offen offset:2048 lds
  buffer_load_dwordx4 v13, s[24:27], s77 offen offset:3072 lds
  v_mfma_f32_16x16x32_bf16 v[104:107], v[156:159], v[204:207], v[104:107]
  v_mfma_f32_16x16x32_bf16 v[108:111], v[156:159], v[208:211], v[108:111]
  v_mfma_f32_16x16x32_bf16 v[112:115], v[160:163], v[200:203], v[112:115]
  v_mfma_f32_16x16x32_bf16 v[116:119], v[160:163], v[204:207], v[116:119]
  v_mfma_f32_16x16x32_bf16 v[120:123], v[160:163], v[208:211], v[120:123]
  v_mfma_f32_16x16x32_bf16 v[124:127], v[164:167], v[200:203], v[124:127]
  v_mfma_f32_16x16x32_bf16 v[128:131], v[164:167], v[204:207], v[128:131]
  v_mfma_f32_16x16x32_bf16 v[132:135], v[164:167], v[208:211], v[132:135]
  s_mov_b32 s72, 6
L_proj_39:
  s_and_b32 s74, s71, 1
  s_lshl_b32 s74, s74, 6
  s_lshr_b32 s75, s71, 1
  v_xor_b32 v22, s74, v23
  s_mul_i32 s75, s75, 6144
  v_add_u32 v22, s75, v22
  s_add_u32 s71, s71, 1
  s_and_b32 s71, s71, 15
  s_waitcnt vmcnt(4)
  ds_read_b64_tr_b16 v[136:137], v18
  ds_read_b64_tr_b16 v[140:141], v19
  ds_read_b64_tr_b16 v[144:145], v20
  ds_read_b64_tr_b16 v[148:149], v21
  ds_read_b64_tr_b16 v[152:153], v6
  ds_read_b64_tr_b16 v[156:157], v7
  ds_read_b64_tr_b16 v[160:161], v38
  ds_read_b64_tr_b16 v[164:165], v39
  v_mfma_f32_16x16x32_bf16 v[40:43], v[168:171], v[212:215], v[40:43]
  v_mfma_f32_16x16x32_bf16 v[44:47], v[168:171], v[216:219], v[44:47]
  v_mfma_f32_16x16x32_bf16 v[48:51], v[168:171], v[220:223], v[48:51]
  v_mfma_f32_16x16x32_bf16 v[52:55], v[172:175], v[212:215], v[52:55]
  v_mfma_f32_16x16x32_bf16 v[56:59], v[172:175], v[216:219], v[56:59]
  v_mfma_f32_16x16x32_bf16 v[60:63], v[172:175], v[220:223], v[60:63]
  v_mfma_f32_16x16x32_bf16 v[64:67], v[176:179], v[212:215], v[64:67]
  s_waitcnt lgkmcnt(0)
  s_mul_i32 s77, s70, 262144
  s_add_u32 s77, s77, s69
  s_add_u32 s70, s70, 1
  s_and_b32 s70, s70, 15
  s_mov_b32 m0, s73
  s_nop 0
  buffer_load_dwordx4 v10, s[24:27], s77 offen lds
  buffer_load_dwordx4 v11, s[24:27], s77 offen offset:1024 lds
  buffer_load_dwordx4 v12, s[24:27], s77 offen offset:2048 lds
  buffer_load_dwordx4 v13, s[24:27], s77 offen offset:3072 lds
  s_waitcnt vmcnt(4)
  ds_read_b64_tr_b16 v[138:139], v18 offset:4096
  ds_read_b64_tr_b16 v[142:143], v19 offset:4096
  ds_read_b64_tr_b16 v[146:147], v20 offset:4096
  ds_read_b64_tr_b16 v[150:151], v21 offset:4096
  ds_read_b64_tr_b16 v[154:155], v6 offset:4096
  ds_read_b64_tr_b16 v[158:159], v7 offset:4096
  ds_read_b64_tr_b16 v[162:163], v38 offset:4096
  ds_read_b64_tr_b16 v[166:167], v39 offset:4096
  ds_read_b128 v[200:203], v22 offset:0
  ds_read_b128 v[204:207], v22 offset:2048
  ds_read_b128 v[208:211], v22 offset:4096
  v_mfma_f32_16x16x32_bf16 v[68:71], v[176:179], v[216:219], v[68:71]
  v_mfma_f32_16x16x32_bf16 v[72:75], v[176:179], v[220:223], v[72:75]
  v_mfma_f32_16x16x32_bf16 v[76:79], v[180:183], v[212:215], v[76:79]
  v_mfma_f32_16x16x32_bf16 v[80:83], v[180:183], v[216:219], v[80:83]
  v_mfma_f32_16x16x32_bf16 v[84:87], v[180:183], v[220:223], v[84:87]
  v_mfma_f32_16x16x32_bf16 v[88:91], v[184:187], v[212:215], v[88:91]
  v_mfma_f32_16x16x32_bf16 v[92:95], v[184:187], v[216:219], v[92:95]
  v_mfma_f32_16x16x32_bf16 v[96:99], v[184:187], v[220:223], v[96:99]
  v_mfma_f32_16x16x32_bf16 v[100:103], v[188:191], v[212:215], v[100:103]
  s_waitcnt lgkmcnt(0)
  s_add_u32 s77, s77, 32768
  s_add_u32 m0, s73, 4096
  s_nop 0
  buffer_load_dwordx4 v10, s[24:27], s77 offen lds
  buffer_load_dwordx4 v11, s[24:27], s77 offen offset:1024 lds
  buffer_load_dwordx4 v12, s[24:27], s77 offen offset:2048 lds
  buffer_load_dwordx4 v13, s[24:27], s77 offen offset:3072 lds
  v_mfma_f32_16x16x32_bf16 v[104:107], v[188:191], v[216:219], v[104:107]
  v_mfma_f32_16x16x32_bf16 v[108:111], v[188:191], v[220:223], v[108:111]
  v_mfma_f32_16x16x32_bf16 v[112:115], v[192:195], v[212:215], v[112:115]
  v_mfma_f32_16x16x32_bf16 v[116:119], v[192:195], v[216:219], v[116:119]
  v_mfma_f32_16x16x32_bf16 v[120:123], v[192:195], v[220:223], v[120:123]
  v_mfma_f32_16x16x32_bf16 v[124:127], v[196:199], v[212:215], v[124:127]
  v_mfma_f32_16x16x32_bf16 v[128:131], v[196:199], v[216:219], v[128:131]
  v_mfma_f32_16x16x32_bf16 v[132:135], v[196:199], v[220:223], v[132:135]
  s_and_b32 s74, s71, 1
  s_lshl_b32 s74, s74, 6
  s_lshr_b32 s75, s71, 1
  v_xor_b32 v22, s74, v23
  s_mul_i32 s75, s75, 6144
  v_add_u32 v22, s75, v22
  s_add_u32 s71, s71, 1
  s_and_b32 s71, s71, 15
  s_waitcnt vmcnt(4)
  ds_read_b64_tr_b16 v[168:169], v18
  ds_read_b64_tr_b16 v[172:173], v19
  ds_read_b64_tr_b16 v[176:177], v20
  ds_read_b64_tr_b16 v[180:181], v21
  ds_read_b64_tr_b16 v[184:185], v6
  ds_read_b64_tr_b16 v[188:189], v7
  ds_read_b64_tr_b16 v[192:193], v38
  ds_read_b64_tr_b16 v[196:197], v39
  v_mfma_f32_16x16x32_bf16 v[40:43], v[136:139], v[200:203], v[40:43]
  v_mfma_f32_16x16x32_bf16 v[44:47], v[136:139], v[204:207], v[44:47]
  v_mfma_f32_16x16x32_bf16 v[48:51], v[136:139], v[208:211], v[48:51]
  v_mfma_f32_16x16x32_bf16 v[52:55], v[140:143], v[200:203], v[52:55]
  v_mfma_f32_16x16x32_bf16 v[56:59], v[140:143], v[204:207], v[56:59]
  v_mfma_f32_16x16x32_bf16 v[60:63], v[140:143], v[208:211], v[60:63]
  v_mfma_f32_16x16x32_bf16 v[64:67], v[144:147], v[200:203], v[64:67]
  s_waitcnt lgkmcnt(0)
  s_mul_i32 s77, s70, 262144
  s_add_u32 s77, s77, s69
  s_add_u32 s70, s70, 1
  s_and_b32 s70, s70, 15
  s_mov_b32 m0, s73
  s_nop 0
  buffer_load_dwordx4 v10, s[24:27], s77 offen lds
  buffer_load_dwordx4 v11, s[24:27], s77 offen offset:1024 lds
  buffer_load_dwordx4 v12, s[24:27], s77 offen offset:2048 lds
  buffer_load_dwordx4 v13, s[24:27], s77 offen offset:3072 lds
  s_waitcnt vmcnt(4)
  ds_read_b64_tr_b16 v[170:171], v18 offset:4096
  ds_read_b64_tr_b16 v[174:175], v19 offset:4096
  ds_read_b64_tr_b16 v[178:179], v20 offset:4096
  ds_read_b64_tr_b16 v[182:183], v21 offset:4096
  ds_read_b64_tr_b16 v[186:187], v6 offset:4096
  ds_read_b64_tr_b16 v[190:191], v7 offset:4096
  ds_read_b64_tr_b16 v[194:195], v38 offset:4096
  ds_read_b64_tr_b16 v[198:199], v39 offset:4096
  ds_read_b128 v[212:215], v22 offset:0
  ds_read_b128 v[216:219], v22 offset:2048
  ds_read_b128 v[220:223], v22 offset:4096
  v_mfma_f32_16x16x32_bf16 v[68:71], v[144:147], v[204:207], v[68:71]
  v_mfma_f32_16x16x32_bf16 v[72:75], v[144:147], v[208:211], v[72:75]
  v_mfma_f32_16x16x32_bf16 v[76:79], v[148:151], v[200:203], v[76:79]
  v_mfma_f32_16x16x32_bf16 v[80:83], v[148:151], v[204:207], v[80:83]
  v_mfma_f32_16x16x32_bf16 v[84:87], v[148:151], v[208:211], v[84:87]
  v_mfma_f32_16x16x32_bf16 v[88:91], v[152:155], v[200:203], v[88:91]
  v_mfma_f32_16x16x32_bf16 v[92:95], v[152:155], v[204:207], v[92:95]
  v_mfma_f32_16x16x32_bf16 v[96:99], v[152:155], v[208:211], v[96:99]
  v_mfma_f32_16x16x32_bf16 v[100:103], v[156:159], v[200:203], v[100:103]
  s_waitcnt lgkmcnt(0)
  s_add_u32 s77, s77, 32768
  s_add_u32 m0, s73, 4096
  s_nop 0
  buffer_load_dwordx4 v10, s[24:27], s77 offen lds
  buffer_load_dwordx4 v11, s[24:27], s77 offen offset:1024 lds
  buffer_load_dwordx4 v12, s[24:27], s77 offen offset:2048 lds
  buffer_load_dwordx4 v13, s[24:27], s77 offen offset:3072 lds
  v_mfma_f32_16x16x32_bf16 v[104:107], v[156:159], v[204:207], v[104:107]
  v_mfma_f32_16x16x32_bf16 v[108:111], v[156:159], v[208:211], v[108:111]
  v_mfma_f32_16x16x32_bf16 v[112:115], v[160:163], v[200:203], v[112:115]
  v_mfma_f32_16x16x32_bf16 v[116:119], v[160:163], v[204:207], v[116:119]
  v_mfma_f32_16x16x32_bf16 v[120:123], v[160:163], v[208:211], v[120:123]
  v_mfma_f32_16x16x32_bf16 v[124:127], v[164:167], v[200:203], v[124:127]
  v_mfma_f32_16x16x32_bf16 v[128:131], v[164:167], v[204:207], v[128:131]
  v_mfma_f32_16x16x32_bf16 v[132:135], v[164:167], v[208:211], v[132:135]
  s_sub_u32 s72, s72, 1
  s_cmp_lg_u32 s72, 0
  s_cbranch_scc1 L_proj_39
  s_and_b32 s74, s71, 1
  s_lshl_b32 s74, s74, 6
  s_lshr_b32 s75, s71, 1
  v_xor_b32 v22, s74, v23
  s_mul_i32 s75, s75, 6144
  v_add_u32 v22, s75, v22
  s_add_u32 s71, s71, 1
  s_and_b32 s71, s71, 15
  s_waitcnt vmcnt(4)
  ds_read_b64_tr_b16 v[136:137], v18
  ds_read_b64_tr_b16 v[140:141], v19
  ds_read_b64_tr_b16 v[144:145], v20
  ds_read_b64_tr_b16 v[148:149], v21
  ds_read_b64_tr_b16 v[152:153], v6
  ds_read_b64_tr_b16 v[156:157], v7
  ds_read_b64_tr_b16 v[160:161], v38
  ds_read_b64_tr_b16 v[164:165], v39
  v_mfma_f32_16x16x32_bf16 v[40:43], v[168:171], v[212:215], v[40:43]
  v_mfma_f32_16x16x32_bf16 v[44:47], v[168:171], v[216:219], v[44:47]
  v_mfma_f32_16x16x32_bf16 v[48:51], v[168:171], v[220:223], v[48:51]
  v_mfma_f32_16x16x32_bf16 v[52:55], v[172:175], v[212:215], v[52:55]
  v_mfma_f32_16x16x32_bf16 v[56:59], v[172:175], v[216:219], v[56:59]
  v_mfma_f32_16x16x32_bf16 v[60:63], v[172:175], v[220:223], v[60:63]
  v_mfma_f32_16x16x32_bf16 v[64:67], v[176:179], v[212:215], v[64:67]
  s_waitcnt lgkmcnt(0)
  s_mul_i32 s77, s70, 262144
  s_add_u32 s77, s77, s69
  s_add_u32 s70, s70, 1
  s_and_b32 s70, s70, 15
  s_mov_b32 m0, s73
  s_nop 0
  buffer_load_dwordx4 v10, s[24:27], s77 offen lds
  buffer_load_dwordx4 v11, s[24:27], s77 offen offset:1024 lds
  buffer_load_dwordx4 v12, s[24:27], s77 offen offset:2048 lds
  buffer_load_dwordx4 v13, s[24:27], s77 offen offset:3072 lds
  s_waitcnt vmcnt(4)
  ds_read_b64_tr_b16 v[138:139], v18 offset:4096
  ds_read_b64_tr_b16 v[142:143], v19 offset:4096
  ds_read_b64_tr_b16 v[146:147], v20 offset:4096
  ds_read_b64_tr_b16 v[150:151], v21 offset:4096
  ds_read_b64_tr_b16 v[154:155], v6 offset:4096
  ds_read_b64_tr_b16 v[158:159], v7 offset:4096
  ds_read_b64_tr_b16 v[162:163], v38 offset:4096
  ds_read_b64_tr_b16 v[166:167], v39 offset:4096
  ds_read_b128 v[200:203], v22 offset:0
  ds_read_b128 v[204:207], v22 offset:2048
  ds_read_b128 v[208:211], v22 offset:4096
  v_mfma_f32_16x16x32_bf16 v[68:71], v[176:179], v[216:219], v[68:71]
  v_mfma_f32_16x16x32_bf16 v[72:75], v[176:179], v[220:223], v[72:75]
  v_mfma_f32_16x16x32_bf16 v[76:79], v[180:183], v[212:215], v[76:79]
  v_mfma_f32_16x16x32_bf16 v[80:83], v[180:183], v[216:219], v[80:83]
  v_mfma_f32_16x16x32_bf16 v[84:87], v[180:183], v[220:223], v[84:87]
  v_mfma_f32_16x16x32_bf16 v[88:91], v[184:187], v[212:215], v[88:91]
  v_mfma_f32_16x16x32_bf16 v[92:95], v[184:187], v[216:219], v[92:95]
  v_mfma_f32_16x16x32_bf16 v[96:99], v[184:187], v[220:223], v[96:99]
  v_mfma_f32_16x16x32_bf16 v[100:103], v[188:191], v[212:215], v[100:103]
  s_waitcnt lgkmcnt(0)
  s_add_u32 s77, s77, 32768
  s_add_u32 m0, s73, 4096
  s_nop 0
  buffer_load_dwordx4 v10, s[24:27], s77 offen lds
  buffer_load_dwordx4 v11, s[24:27], s77 offen offset:1024 lds
  buffer_load_dwordx4 v12, s[24:27], s77 offen offset:2048 lds
  buffer_load_dwordx4 v13, s[24:27], s77 offen offset:3072 lds
  s_mov_b64 exec, 1
  ds_add_u32 v24, v25 offset:64
  s_mov_b64 exec, -1
  v_mfma_f32_16x16x32_bf16 v[104:107], v[188:191], v[216:219], v[104:107]
  v_mfma_f32_16x16x32_bf16 v[108:111], v[188:191], v[220:223], v[108:111]
  v_mfma_f32_16x16x32_bf16 v[112:115], v[192:195], v[212:215], v[112:115]
  v_mfma_f32_16x16x32_bf16 v[116:119], v[192:195], v[216:219], v[116:119]
  v_mfma_f32_16x16x32_bf16 v[120:123], v[192:195], v[220:223], v[120:123]
  v_mfma_f32_16x16x32_bf16 v[124:127], v[196:199], v[212:215], v[124:127]
  v_mfma_f32_16x16x32_bf16 v[128:131], v[196:199], v[216:219], v[128:131]
  v_mfma_f32_16x16x32_bf16 v[132:135], v[196:199], v[220:223], v[132:135]
  s_and_b32 s74, s71, 1
  s_lshl_b32 s74, s74, 6
  s_lshr_b32 s75, s71, 1
  v_xor_b32 v22, s74, v23
  s_mul_i32 s75, s75, 6144
  v_add_u32 v22, s75, v22
  s_add_u32 s71, s71, 1
  s_and_b32 s71, s71, 15
  s_waitcnt vmcnt(4)
  ds_read_b64_tr_b16 v[168:169], v18
  ds_read_b64_tr_b16 v[172:173], v19
  ds_read_b64_tr_b16 v[176:177], v20
  ds_read_b64_tr_b16 v[180:181], v21
  ds_read_b64_tr_b16 v[184:185], v6
  ds_read_b64_tr_b16 v[188:189], v7
  ds_read_b64_tr_b16 v[192:193], v38
  ds_read_b64_tr_b16 v[196:197], v39
  v_mfma_f32_16x16x32_bf16 v[40:43], v[136:139], v[200:203], v[40:43]
  v_mfma_f32_16x16x32_bf16 v[44:47], v[136:139], v[204:207], v[44:47]
  v_mfma_f32_16x16x32_bf16 v[48:51], v[136:139], v[208:211], v[48:51]
  v_mfma_f32_16x16x32_bf16 v[52:55], v[140:143], v[200:203], v[52:55]
  v_mfma_f32_16x16x32_bf16 v[56:59], v[140:143], v[204:207], v[56:59]
  v_mfma_f32_16x16x32_bf16 v[60:63], v[140:143], v[208:211], v[60:63]
  v_mfma_f32_16x16x32_bf16 v[64:67], v[144:147], v[200:203], v[64:67]
  s_waitcnt vmcnt(0)
  ds_read_b64_tr_b16 v[170:171], v18 offset:4096
  ds_read_b64_tr_b16 v[174:175], v19 offset:4096
  ds_read_b64_tr_b16 v[178:179], v20 offset:4096
  ds_read_b64_tr_b16 v[182:183], v21 offset:4096
  ds_read_b64_tr_b16 v[186:187], v6 offset:4096
  ds_read_b64_tr_b16 v[190:191], v7 offset:4096
  ds_read_b64_tr_b16 v[194:195], v38 offset:4096
  ds_read_b64_tr_b16 v[198:199], v39 offset:4096
  ds_read_b128 v[212:215], v22 offset:0
  ds_read_b128 v[216:219], v22 offset:2048
  ds_read_b128 v[220:223], v22 offset:4096
  v_mfma_f32_16x16x32_bf16 v[68:71], v[144:147], v[204:207], v[68:71]
  v_mfma_f32_16x16x32_bf16 v[72:75], v[144:147], v[208:211], v[72:75]
  v_mfma_f32_16x16x32_bf16 v[76:79], v[148:151], v[200:203], v[76:79]
  v_mfma_f32_16x16x32_bf16 v[80:83], v[148:151], v[204:207], v[80:83]
  v_mfma_f32_16x16x32_bf16 v[84:87], v[148:151], v[208:211], v[84:87]
  v_mfma_f32_16x16x32_bf16 v[88:91], v[152:155], v[200:203], v[88:91]
  v_mfma_f32_16x16x32_bf16 v[92:95], v[152:155], v[204:207], v[92:95]
  v_mfma_f32_16x16x32_bf16 v[96:99], v[152:155], v[208:211], v[96:99]
  v_mfma_f32_16x16x32_bf16 v[100:103], v[156:159], v[200:203], v[100:103]
  s_waitcnt lgkmcnt(0)
  v_mfma_f32_16x16x32_bf16 v[104:107], v[156:159], v[204:207], v[104:107]
  v_mfma_f32_16x16x32_bf16 v[108:111], v[156:159], v[208:211], v[108:111]
  v_mfma_f32_16x16x32_bf16 v[112:115], v[160:163], v[200:203], v[112:115]
  v_mfma_f32_16x16x32_bf16 v[116:119], v[160:163], v[204:207], v[116:119]
  v_mfma_f32_16x16x32_bf16 v[120:123], v[160:163], v[208:211], v[120:123]
  v_mfma_f32_16x16x32_bf16 v[124:127], v[164:167], v[200:203], v[124:127]
  v_mfma_f32_16x16x32_bf16 v[128:131], v[164:167], v[204:207], v[128:131]
  v_mfma_f32_16x16x32_bf16 v[132:135], v[164:167], v[208:211], v[132:135]
  s_lshl_b32 s67, s81, 13
  s_add_u32 s67, s67, s83
  s_mov_b32 m0, s73
  s_nop 0
  buffer_load_dwordx4 v8, s[16:19], s67 offen nt lds
  buffer_load_dwordx4 v9, s[16:19], s67 offen offset:1024 nt lds
  buffer_load_dwordx4 v8, s[16:19], s67 offen offset:2048 nt lds
  buffer_load_dwordx4 v9, s[16:19], s67 offen offset:3072 nt lds
  s_add_u32 s81, s81, 1
  s_and_b32 s81, s81, 15
  s_lshl_b32 s67, s81, 13
  s_add_u32 s67, s67, s83
  s_add_u32 m0, s73, 4096
  s_nop 0
  buffer_load_dwordx4 v8, s[16:19], s67 offen nt lds
  buffer_load_dwordx4 v9, s[16:19], s67 offen offset:1024 nt lds
  buffer_load_dwordx4 v8, s[16:19], s67 offen offset:2048 nt lds
  buffer_load_dwordx4 v9, s[16:19], s67 offen offset:3072 nt lds
  s_add_u32 s81, s81, 1
  s_and_b32 s81, s81, 15
  s_mov_b32 s12, s48
  s_mov_b32 s13, s49
  s_mov_b32 s14, 4194304
  s_mov_b32 s15, 0x20000
  v_lshlrev_b32 v37, 4, v1
  s_lshl_b32 s74, s6, 19
  s_lshl_b32 s75, s5, 14
  s_add_u32 s74, s74, s75
  s_lshl_b32 s75, s4, 12
  s_add_u32 s74, s74, s75
  s_mov_b32 m0, 147712
  s_nop 0
  buffer_load_dwordx4 v37, s[12:15], s74 offen offset:0 lds
  buffer_load_dwordx4 v37, s[12:15], s74 offen offset:1024 lds
  buffer_load_dwordx4 v37, s[12:15], s74 offen offset:2048 lds
  buffer_load_dwordx4 v37, s[12:15], s74 offen offset:3072 lds
  s_call_b64 s[8:9], L_projend
  s_call_b64 s[8:9], L_attn_zero
  s_setprio 3
  v_lshrrev_b32 v2, 4, v1
  v_lshlrev_b32 v2, 10, v2
  v_and_b32 v3, 0xff, v8
  v_add_u32 v10, v2, v3
  v_and_b32 v3, 0xff, v9
  v_add_u32 v3, 7168, v3
  v_add_u32 v11, v2, v3
  v_and_b32 v3, 0xff, v8
  v_add_u32 v3, 14336, v3
  v_add_u32 v12, v2, v3
  v_and_b32 v3, 0xff, v9
  v_add_u32 v3, 21504, v3
  v_add_u32 v13, v2, v3
  s_mov_b32 s24, s48
  s_mov_b32 s25, s49
  s_mov_b32 s26, 4194304
  s_mov_b32 s27, 0x20000
  s_lshl_b32 s69, s6, 19
  s_lshl_b32 s74, s4, 8
  s_add_u32 s69, s69, s74
  s_sub_u32 s75, 16384, s73
  v_add_u32 v18, s75, v18
  v_add_u32 v19, s75, v19
  v_add_u32 v20, s75, v20
  v_add_u32 v21, s75, v21
  v_add_u32 v6, s75, v6
  v_add_u32 v7, s75, v7
  v_add_u32 v38, s75, v38
  v_add_u32 v39, s75, v39
  s_mov_b32 s76, 4
  s_waitcnt vmcnt(8)
  s_mov_b64 exec, 1
  ds_add_u32 v24, v25 offset:4
  s_mov_b64 exec, -1
L_spin_40:
  ds_read_b32 v2, v24 offset:4
  s_waitcnt lgkmcnt(0)
  v_readfirstlane_b32 s74, v2
  s_nop 0
  s_cmp_ge_u32 s74, 8
  s_cbranch_scc1 L_spun_41
  s_sleep 1
  s_branch L_spin_40
L_spun_41:
  s_lshl_b32 s67, s81, 13
  s_add_u32 s67, s67, s83
  s_mov_b32 m0, s68
  s_nop 0
  buffer_load_dwordx4 v8, s[16:19], s67 offen nt lds
  buffer_load_dwordx4 v9, s[16:19], s67 offen offset:1024 nt lds
  buffer_load_dwordx4 v8, s[16:19], s67 offen offset:2048 nt lds
  buffer_load_dwordx4 v9, s[16:19], s67 offen offset:3072 nt lds
  s_add_u32 s81, s81, 1
  s_and_b32 s81, s81, 15
  s_mov_b32 s80, 13
  s_mov_b32 s72, 3
L_attnA_42:
  s_add_u32 s76, s76, 4
L_spin_43:
  ds_read_b32 v2, v24 offset:4
  s_waitcnt lgkmcnt(0)
  v_readfirstlane_b32 s74, v2
  s_nop 0
  s_cmp_ge_u32 s74, s76
  s_cbranch_scc1 L_spun_44
  s_sleep 1
  s_branch L_spin_43
L_spun_44:
  s_cmp_eq_u32 s80, 0
  s_cbranch_scc1 L_noiss_45
  s_lshl_b32 s67, s81, 13
  s_add_u32 s67, s67, s83
  s_add_u32 m0, s68, 4096
  s_nop 0
  buffer_load_dwordx4 v8, s[16:19], s67 offen nt lds
  buffer_load_dwordx4 v9, s[16:19], s67 offen offset:1024 nt lds
  buffer_load_dwordx4 v8, s[16:19], s67 offen offset:2048 nt lds
  buffer_load_dwordx4 v9, s[16:19], s67 offen offset:3072 nt lds
  s_add_u32 s81, s81, 1
  s_and_b32 s81, s81, 15
  s_sub_u32 s80, s80, 1
  s_mov_b32 s82, 1
  s_branch L_iss_46
L_noiss_45:
  s_mov_b32 s82, 0
L_iss_46:
  ds_read_b128 v[224:227], v14 offset:0
  ds_read_b128 v[228:231], v15 offset:0
  ds_read_b128 v[232:235], v16 offset:0
  ds_read_b128 v[236:239], v17 offset:0
  ds_read_b128 v[240:243], v14 offset:8192
  ds_read_b128 v[244:247], v15 offset:8192
  ds_read_b128 v[248:251], v16 offset:8192
  ds_read_b128 v[252:255], v17 offset:8192
  s_waitcnt lgkmcnt(4)
  v_mfma_f32_16x16x32_bf16 v[200:203], v[224:227], v[136:139], 0
  v_mfma_f32_16x16x32_bf16 v[200:203], v[228:231], v[148:151], v[200:203]
  v_mfma_f32_16x16x32_bf16 v[200:203], v[232:235], v[160:163], v[200:203]
  v_mfma_f32_16x16x32_bf16 v[200:203], v[236:239], v[172:175], v[200:203]
  s_waitcnt lgkmcnt(0)
  v_mfma_f32_16x16x32_bf16 v[212:215], v[240:243], v[136:139], 0
  v_mfma_f32_16x16x32_bf16 v[212:215], v[244:247], v[148:151], v[212:215]
  v_mfma_f32_16x16x32_bf16 v[212:215], v[248:251], v[160:163], v[212:215]
  v_mfma_f32_16x16x32_bf16 v[212:215], v[252:255], v[172:175], v[212:215]
  v_mfma_f32_16x16x32_bf16 v[204:207], v[224:227], v[140:143], 0
  v_mfma_f32_16x16x32_bf16 v[204:207], v[228:231], v[152:155], v[204:207]
  v_mfma_f32_16x16x32_bf16 v[204:207], v[232:235], v[164:167], v[204:207]
  v_mfma_f32_16x16x32_bf16 v[204:207], v[236:239], v[176:179], v[204:207]
  s_cmp_eq_u32 s82, 0
  s_cbranch_scc1 L_v0_47
  s_waitcnt vmcnt(8)
  s_branch L_v8_48
L_v0_47:
  s_waitcnt vmcnt(0)
L_v8_48:
  s_mov_b64 exec, 1
  ds_add_u32 v24, v25 offset:4
  s_mov_b64 exec, -1
  v_mfma_f32_16x16x32_bf16 v[216:219], v[240:243], v[140:143], 0
  v_max3_f32 v32, v200, v201, v202
  v_max3_f32 v35, v203, v212, v213
  v_mfma_f32_16x16x32_bf16 v[216:219], v[244:247], v[152:155], v[216:219]
  v_max3_f32 v32, v32, v214, v215
  v_max_f32 v32, v32, v35
  v_mfma_f32_16x16x32_bf16 v[216:219], v[248:251], v[164:167], v[216:219]
  v_fma_f32 v35, v32, s66, v26
  v_cmp_lt_f32 vcc, s78, v35
  s_cbranch_vccz L_fast_49
  s_call_b64 s[8:9], L_rescale0
L_fast_49:
  v_mfma_f32_16x16x32_bf16 v[216:219], v[252:255], v[176:179], v[216:219]
  v_fma_f32 v200, v200, s66, v26
  v_fma_f32 v201, v201, s66, v26
  v_mfma_f32_16x16x32_bf16 v[208:211], v[224:227], v[144:147], 0
  v_exp_f32 v200, v200
  v_mfma_f32_16x16x32_bf16 v[208:211], v[228:231], v[156:159], v[208:211]
  v_fma_f32 v202, v202, s66, v26
  v_exp_f32 v201, v201
  v_mfma_f32_16x16x32_bf16 v[208:211], v[232:235], v[168:171], v[208:211]
  v_fma_f32 v203, v203, s66, v26
  v_exp_f32 v202, v202
  v_mfma_f32_16x16x32_bf16 v[208:211], v[236:239], v[180:183], v[208:211]
  v_fma_f32 v212, v212, s66, v26
  v_exp_f32 v203, v203
  v_mfma_f32_16x16x32_bf16 v[220:223], v[240:243], v[144:147], 0
  v_fma_f32 v213, v213, s66, v26
  v_exp_f32 v212, v212
  v_mfma_f32_16x16x32_bf16 v[220:223], v[244:247], v[156:159], v[220:223]
  v_fma_f32 v214, v214, s66, v26
  v_exp_f32 v213, v213
  v_mfma_f32_16x16x32_bf16 v[220:223], v[248:251], v[168:171], v[220:223]
  v_fma_f32 v215, v215, s66, v26
  v_exp_f32 v214, v214
  v_mfma_f32_16x16x32_bf16 v[220:223], v[252:255], v[180:183], v[220:223]
  v_add_f32 v32, v200, v201
  v_exp_f32 v215, v215
  ds_read_b64_tr_b16 v[224:225], v18 offset:0
  ds_read_b64_tr_b16 v[228:229], v19 offset:0
  ds_read_b64_tr_b16 v[232:233], v20 offset:0
  ds_read_b64_tr_b16 v[236:237], v21 offset:0
  ds_read_b64_tr_b16 v[240:241], v6 offset:0
  ds_read_b64_tr_b16 v[244:245], v7 offset:0
  ds_read_b64_tr_b16 v[248:249], v38 offset:0
  ds_read_b64_tr_b16 v[252:253], v39 offset:0
  ds_read_b64_tr_b16 v[226:227], v18 offset:8192
  ds_read_b64_tr_b16 v[230:231], v19 offset:8192
  ds_read_b64_tr_b16 v[234:235], v20 offset:8192
  ds_read_b64_tr_b16 v[238:239], v21 offset:8192
  ds_read_b64_tr_b16 v[242:243], v6 offset:8192
  ds_read_b64_tr_b16 v[246:247], v7 offset:8192
  ds_read_b64_tr_b16 v[250:251], v38 offset:8192
  ds_read_b64_tr_b16 v[254:255], v39 offset:8192
  v_add_f32 v35, v202, v203
  v_add_f32 v29, v29, v212
  v_add_f32 v32, v32, v213
  v_add_f32 v35, v35, v214
  v_add_f32 v29, v29, v215
  v_cvt_pk_bf16_f32 v200, v200, v201
  v_add_f32 v32, v32, v35
  v_cvt_pk_bf16_f32 v201, v202, v203
  v_cvt_pk_bf16_f32 v202, v212, v213
  v_add_f32 v29, v29, v32
  v_cvt_pk_bf16_f32 v203, v214, v215
  v_max3_f32 v33, v204, v205, v206
  v_max3_f32 v36, v207, v216, v217
  v_max3_f32 v33, v33, v218, v219
  v_max_f32 v33, v33, v36
  v_fma_f32 v36, v33, s66, v27
  v_cmp_lt_f32 vcc, s78, v36
  s_cbranch_vccz L_fast_50
  s_call_b64 s[8:9], L_rescale1
L_fast_50:
  v_fma_f32 v204, v204, s66, v27
  v_fma_f32 v205, v205, s66, v27
  v_exp_f32 v204, v204
  v_fma_f32 v206, v206, s66, v27
  v_exp_f32 v205, v205
  v_fma_f32 v207, v207, s66, v27
  v_exp_f32 v206, v206
  v_fma_f32 v216, v216, s66, v27
  v_exp_f32 v207, v207
  v_fma_f32 v217, v217, s66, v27
  v_exp_f32 v216, v216
  v_fma_f32 v218, v218, s66, v27
  v_exp_f32 v217, v217
  v_fma_f32 v219, v219, s66, v27
  v_exp_f32 v218, v218
  v_add_f32 v33, v204, v205
  v_exp_f32 v219, v219
  v_add_f32 v36, v206, v207
  v_add_f32 v30, v30, v216
  v_add_f32 v33, v33, v217
  v_add_f32 v36, v36, v218
  v_add_f32 v30, v30, v219
  v_cvt_pk_bf16_f32 v204, v204, v205
  v_add_f32 v33, v33, v36
  v_cvt_pk_bf16_f32 v205, v206, v207
  v_cvt_pk_bf16_f32 v206, v216, v217
  v_add_f32 v30, v30, v33
  v_cvt_pk_bf16_f32 v207, v218, v219
  s_waitcnt lgkmcnt(0)
  v_mfma_f32_16x16x32_bf16 v[40:43], v[224:227], v[200:203], v[40:43]
  v_max3_f32 v34, v208, v209, v210
  v_max3_f32 v37, v211, v220, v221
  v_max3_f32 v34, v34, v222, v223
  v_mfma_f32_16x16x32_bf16 v[52:55], v[228:231], v[200:203], v[52:55]
  v_max_f32 v34, v34, v37
  v_fma_f32 v37, v34, s66, v28
  v_cmp_lt_f32 vcc, s78, v37
  s_cbranch_vccz L_fast_51
  s_call_b64 s[8:9], L_rescale2
L_fast_51:
  v_mfma_f32_16x16x32_bf16 v[64:67], v[232:235], v[200:203], v[64:67]
  v_fma_f32 v208, v208, s66, v28
  v_fma_f32 v209, v209, s66, v28
  v_exp_f32 v208, v208
  v_mfma_f32_16x16x32_bf16 v[76:79], v[236:239], v[200:203], v[76:79]
  v_fma_f32 v210, v210, s66, v28
  v_exp_f32 v209, v209
  v_mfma_f32_16x16x32_bf16 v[88:91], v[240:243], v[200:203], v[88:91]
  v_fma_f32 v211, v211, s66, v28
  v_exp_f32 v210, v210
  v_mfma_f32_16x16x32_bf16 v[100:103], v[244:247], v[200:203], v[100:103]
  v_fma_f32 v220, v220, s66, v28
  v_exp_f32 v211, v211
  v_mfma_f32_16x16x32_bf16 v[112:115], v[248:251], v[200:203], v[112:115]
  v_fma_f32 v221, v221, s66, v28
  v_exp_f32 v220, v220
  v_mfma_f32_16x16x32_bf16 v[124:127], v[252:255], v[200:203], v[124:127]
  v_fma_f32 v222, v222, s66, v28
  v_exp_f32 v221, v221
  v_mfma_f32_16x16x32_bf16 v[44:47], v[224:227], v[204:207], v[44:47]
  v_fma_f32 v223, v223, s66, v28
  v_exp_f32 v222, v222
  v_mfma_f32_16x16x32_bf16 v[56:59], v[228:231], v[204:207], v[56:59]
  v_add_f32 v34, v208, v209
  v_exp_f32 v223, v223
  v_mfma_f32_16x16x32_bf16 v[68:71], v[232:235], v[204:207], v[68:71]
  v_add_f32 v37, v210, v211
  v_add_f32 v31, v31, v220
  v_add_f32 v34, v34, v221
  v_mfma_f32_16x16x32_bf16 v[80:83], v[236:239], v[204:207], v[80:83]
  v_add_f32 v37, v37, v222
  v_add_f32 v31, v31, v223
  v_cvt_pk_bf16_f32 v208, v208, v209
  v_mfma_f32_16x16x32_bf16 v[92:95], v[240:243], v[204:207], v[92:95]
  v_add_f32 v34, v34, v37
  v_cvt_pk_bf16_f32 v209, v210, v211
  v_cvt_pk_bf16_f32 v210, v220, v221
  v_mfma_f32_16x16x32_bf16 v[104:107], v[244:247], v[204:207], v[104:107]
  v_add_f32 v31, v31, v34
  v_cvt_pk_bf16_f32 v211, v222, v223
  v_mfma_f32_16x16x32_bf16 v[116:119], v[248:251], v[204:207], v[116:119]
  v_mfma_f32_16x16x32_bf16 v[128:131], v[252:255], v[204:207], v[128:131]
  s_nop 1
  v_mfma_f32_16x16x32_bf16 v[48:51], v[224:227], v[208:211], v[48:51]
  v_mfma_f32_16x16x32_bf16 v[60:63], v[228:231], v[208:211], v[60:63]
  v_mfma_f32_16x16x32_bf16 v[72:75], v[232:235], v[208:211], v[72:75]
  v_mfma_f32_16x16x32_bf16 v[84:87], v[236:239], v[208:211], v[84:87]
  v_mfma_f32_16x16x32_bf16 v[96:99], v[240:243], v[208:211], v[96:99]
  v_mfma_f32_16x16x32_bf16 v[108:111], v[244:247], v[208:211], v[108:111]
  v_mfma_f32_16x16x32_bf16 v[120:123], v[248:251], v[208:211], v[120:123]
  v_mfma_f32_16x16x32_bf16 v[132:135], v[252:255], v[208:211], v[132:135]
  s_add_u32 s76, s76, 4
L_spin_52:
  ds_read_b32 v2, v24 offset:4
  s_waitcnt lgkmcnt(0)
  v_readfirstlane_b32 s74, v2
  s_nop 0
  s_cmp_ge_u32 s74, s76
  s_cbranch_scc1 L_spun_53
  s_sleep 1
  s_branch L_spin_52
L_spun_53:
  s_cmp_eq_u32 s80, 0
  s_cbranch_scc1 L_noiss_54
  s_lshl_b32 s67, s81, 13
  s_add_u32 s67, s67, s83
  s_add_u32 m0, s68, 8192
  s_nop 0
  buffer_load_dwordx4 v8, s[16:19], s67 offen nt lds
  buffer_load_dwordx4 v9, s[16:19], s67 offen offset:1024 nt lds
  buffer_load_dwordx4 v8, s[16:19], s67 offen offset:2048 nt lds
  buffer_load_dwordx4 v9, s[16:19], s67 offen offset:3072 nt lds
  s_add_u32 s81, s81, 1
  s_and_b32 s81, s81, 15
  s_sub_u32 s80, s80, 1
  s_mov_b32 s82, 1
  s_branch L_iss_55
L_noiss_54:
  s_mov_b32 s82, 0
L_iss_55:
  ds_read_b128 v[224:227], v14 offset:4096
  ds_read_b128 v[228:231], v15 offset:4096
  ds_read_b128 v[232:235], v16 offset:4096
  ds_read_b128 v[236:239], v17 offset:4096
  ds_read_b128 v[240:243], v14 offset:12288
  ds_read_b128 v[244:247], v15 offset:12288
  ds_read_b128 v[248:251], v16 offset:12288
  ds_read_b128 v[252:255], v17 offset:12288
  s_waitcnt lgkmcnt(4)
  v_mfma_f32_16x16x32_bf16 v[200:203], v[224:227], v[136:139], 0
  v_mfma_f32_16x16x32_bf16 v[200:203], v[228:231], v[148:151], v[200:203]
  v_mfma_f32_16x16x32_bf16 v[200:203], v[232:235], v[160:163], v[200:203]
  v_mfma_f32_16x16x32_bf16 v[200:203], v[236:239], v[172:175], v[200:203]
  s_waitcnt lgkmcnt(0)
  v_mfma_f32_16x16x32_bf16 v[212:215], v[240:243], v[136:139], 0
  v_mfma_f32_16x16x32_bf16 v[212:215], v[244:247], v[148:151], v[212:215]
  v_mfma_f32_16x16x32_bf16 v[212:215], v[248:251], v[160:163], v[212:215]
  v_mfma_f32_16x16x32_bf16 v[212:215], v[252:255], v[172:175], v[212:215]
  v_mfma_f32_16x16x32_bf16 v[204:207], v[224:227], v[140:143], 0
  v_mfma_f32_16x16x32_bf16 v[204:207], v[228:231], v[152:155], v[204:207]
  v_mfma_f32_16x16x32_bf16 v[204:207], v[232:235], v[164:167], v[204:207]
  v_mfma_f32_16x16x32_bf16 v[204:207], v[236:239], v[176:179], v[204:207]
  s_cmp_eq_u32 s82, 0
  s_cbranch_scc1 L_v0_56
  s_waitcnt vmcnt(8)
  s_branch L_v8_57
L_v0_56:
  s_waitcnt vmcnt(0)
L_v8_57:
  s_mov_b64 exec, 1
  ds_add_u32 v24, v25 offset:4
  s_mov_b64 exec, -1
  v_mfma_f32_16x16x32_bf16 v[216:219], v[240:243], v[140:143], 0
  v_max3_f32 v32, v200, v201, v202
  v_max3_f32 v35, v203, v212, v213
  v_mfma_f32_16x16x32_bf16 v[216:219], v[244:247], v[152:155], v[216:219]
  v_max3_f32 v32, v32, v214, v215
  v_max_f32 v32, v32, v35
  v_mfma_f32_16x16x32_bf16 v[216:219], v[248:251], v[164:167], v[216:219]
  v_fma_f32 v35, v32, s66, v26
  v_cmp_lt_f32 vcc, s78, v35
  s_cbranch_vccz L_fast_58
  s_call_b64 s[8:9], L_rescale0
L_fast_58:
  v_mfma_f32_16x16x32_bf16 v[216:219], v[252:255], v[176:179], v[216:219]
  v_fma_f32 v200, v200, s66, v26
  v_fma_f32 v201, v201, s66, v26
  v_mfma_f32_16x16x32_bf16 v[208:211], v[224:227], v[144:147], 0
  v_exp_f32 v200, v200
  v_mfma_f32_16x16x32_bf16 v[208:211], v[228:231], v[156:159], v[208:211]
  v_fma_f32 v202, v202, s66, v26
  v_exp_f32 v201, v201
  v_mfma_f32_16x16x32_bf16 v[208:211], v[232:235], v[168:171], v[208:211]
  v_fma_f32 v203, v203, s66, v26
  v_exp_f32 v202, v202
  v_mfma_f32_16x16x32_bf16 v[208:211], v[236:239], v[180:183], v[208:211]
  v_fma_f32 v212, v212, s66, v26
  v_exp_f32 v203, v203
  v_mfma_f32_16x16x32_bf16 v[220:223], v[240:243], v[144:147], 0
  v_fma_f32 v213, v213, s66, v26
  v_exp_f32 v212, v212
  v_mfma_f32_16x16x32_bf16 v[220:223], v[244:247], v[156:159], v[220:223]
  v_fma_f32 v214, v214, s66, v26
  v_exp_f32 v213, v213
  v_mfma_f32_16x16x32_bf16 v[220:223], v[248:251], v[168:171], v[220:223]
  v_fma_f32 v215, v215, s66, v26
  v_exp_f32 v214, v214
  v_mfma_f32_16x16x32_bf16 v[220:223], v[252:255], v[180:183], v[220:223]
  v_add_f32 v32, v200, v201
  v_exp_f32 v215, v215
  ds_read_b64_tr_b16 v[224:225], v18 offset:4096
  ds_read_b64_tr_b16 v[228:229], v19 offset:4096
  ds_read_b64_tr_b16 v[232:233], v20 offset:4096
  ds_read_b64_tr_b16 v[236:237], v21 offset:4096
  ds_read_b64_tr_b16 v[240:241], v6 offset:4096
  ds_read_b64_tr_b16 v[244:245], v7 offset:4096
  ds_read_b64_tr_b16 v[248:249], v38 offset:4096
  ds_read_b64_tr_b16 v[252:253], v39 offset:4096
  ds_read_b64_tr_b16 v[226:227], v18 offset:12288
  ds_read_b64_tr_b16 v[230:231], v19 offset:12288
  ds_read_b64_tr_b16 v[234:235], v20 offset:12288
  ds_read_b64_tr_b16 v[238:239], v21 offset:12288
  ds_read_b64_tr_b16 v[242:243], v6 offset:12288
  ds_read_b64_tr_b16 v[246:247], v7 offset:12288
  ds_read_b64_tr_b16 v[250:251], v38 offset:12288
  ds_read_b64_tr_b16 v[254:255], v39 offset:12288
  v_add_f32 v35, v202, v203
  v_add_f32 v29, v29, v212
  v_add_f32 v32, v32, v213
  v_add_f32 v35, v35, v214
  v_add_f32 v29, v29, v215
  v_cvt_pk_bf16_f32 v200, v200, v201
  v_add_f32 v32, v32, v35
  v_cvt_pk_bf16_f32 v201, v202, v203
  v_cvt_pk_bf16_f32 v202, v212, v213
  v_add_f32 v29, v29, v32
  v_cvt_pk_bf16_f32 v203, v214, v215
  v_max3_f32 v33, v204, v205, v206
  v_max3_f32 v36, v207, v216, v217
  v_max3_f32 v33, v33, v218, v219
  v_max_f32 v33, v33, v36
  v_fma_f32 v36, v33, s66, v27
  v_cmp_lt_f32 vcc, s78, v36
  s_cbranch_vccz L_fast_59
  s_call_b64 s[8:9], L_rescale1
L_fast_59:
  v_fma_f32 v204, v204, s66, v27
  v_fma_f32 v205, v205, s66, v27
  v_exp_f32 v204, v204
  v_fma_f32 v206, v206, s66, v27
  v_exp_f32 v205, v205
  v_fma_f32 v207, v207, s66, v27
  v_exp_f32 v206, v206
  v_fma_f32 v216, v216, s66, v27
  v_exp_f32 v207, v207
  v_fma_f32 v217, v217, s66, v27
  v_exp_f32 v216, v216
  v_fma_f32 v218, v218, s66, v27
  v_exp_f32 v217, v217
  v_fma_f32 v219, v219, s66, v27
  v_exp_f32 v218, v218
  v_add_f32 v33, v204, v205
  v_exp_f32 v219, v219
  v_add_f32 v36, v206, v207
  v_add_f32 v30, v30, v216
  v_add_f32 v33, v33, v217
  v_add_f32 v36, v36, v218
  v_add_f32 v30, v30, v219
  v_cvt_pk_bf16_f32 v204, v204, v205
  v_add_f32 v33, v33, v36
  v_cvt_pk_bf16_f32 v205, v206, v207
  v_cvt_pk_bf16_f32 v206, v216, v217
  v_add_f32 v30, v30, v33
  v_cvt_pk_bf16_f32 v207, v218, v219
  s_waitcnt lgkmcnt(0)
  v_mfma_f32_16x16x32_bf16 v[40:43], v[224:227], v[200:203], v[40:43]
  v_max3_f32 v34, v208, v209, v210
  v_max3_f32 v37, v211, v220, v221
  v_max3_f32 v34, v34, v222, v223
  v_mfma_f32_16x16x32_bf16 v[52:55], v[228:231], v[200:203], v[52:55]
  v_max_f32 v34, v34, v37
  v_fma_f32 v37, v34, s66, v28
  v_cmp_lt_f32 vcc, s78, v37
  s_cbranch_vccz L_fast_60
  s_call_b64 s[8:9], L_rescale2
L_fast_60:
  v_mfma_f32_16x16x32_bf16 v[64:67], v[232:235], v[200:203], v[64:67]
  v_fma_f32 v208, v208, s66, v28
  v_fma_f32 v209, v209, s66, v28
  v_exp_f32 v208, v208
  v_mfma_f32_16x16x32_bf16 v[76:79], v[236:239], v[200:203], v[76:79]
  v_fma_f32 v210, v210, s66, v28
  v_exp_f32 v209, v209
  v_mfma_f32_16x16x32_bf16 v[88:91], v[240:243], v[200:203], v[88:91]
  v_fma_f32 v211, v211, s66, v28
  v_exp_f32 v210, v210
  v_mfma_f32_16x16x32_bf16 v[100:103], v[244:247], v[200:203], v[100:103]
  v_fma_f32 v220, v220, s66, v28
  v_exp_f32 v211, v211
  v_mfma_f32_16x16x32_bf16 v[112:115], v[248:251], v[200:203], v[112:115]
  v_fma_f32 v221, v221, s66, v28
  v_exp_f32 v220, v220
  v_mfma_f32_16x16x32_bf16 v[124:127], v[252:255], v[200:203], v[124:127]
  v_fma_f32 v222, v222, s66, v28
  v_exp_f32 v221, v221
  v_mfma_f32_16x16x32_bf16 v[44:47], v[224:227], v[204:207], v[44:47]
  v_fma_f32 v223, v223, s66, v28
  v_exp_f32 v222, v222
  v_mfma_f32_16x16x32_bf16 v[56:59], v[228:231], v[204:207], v[56:59]
  v_add_f32 v34, v208, v209
  v_exp_f32 v223, v223
  v_mfma_f32_16x16x32_bf16 v[68:71], v[232:235], v[204:207], v[68:71]
  v_add_f32 v37, v210, v211
  v_add_f32 v31, v31, v220
  v_add_f32 v34, v34, v221
  v_mfma_f32_16x16x32_bf16 v[80:83], v[236:239], v[204:207], v[80:83]
  v_add_f32 v37, v37, v222
  v_add_f32 v31, v31, v223
  v_cvt_pk_bf16_f32 v208, v208, v209
  v_mfma_f32_16x16x32_bf16 v[92:95], v[240:243], v[204:207], v[92:95]
  v_add_f32 v34, v34, v37
  v_cvt_pk_bf16_f32 v209, v210, v211
  v_cvt_pk_bf16_f32 v210, v220, v221
  v_mfma_f32_16x16x32_bf16 v[104:107], v[244:247], v[204:207], v[104:107]
  v_add_f32 v31, v31, v34
  v_cvt_pk_bf16_f32 v211, v222, v223
  v_mfma_f32_16x16x32_bf16 v[116:119], v[248:251], v[204:207], v[116:119]
  v_mfma_f32_16x16x32_bf16 v[128:131], v[252:255], v[204:207], v[128:131]
  s_nop 1
  v_mfma_f32_16x16x32_bf16 v[48:51], v[224:227], v[208:211], v[48:51]
  v_mfma_f32_16x16x32_bf16 v[60:63], v[228:231], v[208:211], v[60:63]
  v_mfma_f32_16x16x32_bf16 v[72:75], v[232:235], v[208:211], v[72:75]
  v_mfma_f32_16x16x32_bf16 v[84:87], v[236:239], v[208:211], v[84:87]
  v_mfma_f32_16x16x32_bf16 v[96:99], v[240:243], v[208:211], v[96:99]
  v_mfma_f32_16x16x32_bf16 v[108:111], v[244:247], v[208:211], v[108:111]
  v_mfma_f32_16x16x32_bf16 v[120:123], v[248:251], v[208:211], v[120:123]
  v_mfma_f32_16x16x32_bf16 v[132:135], v[252:255], v[208:211], v[132:135]
  s_add_u32 s76, s76, 4
L_spin_61:
  ds_read_b32 v2, v24 offset:4
  s_waitcnt lgkmcnt(0)
  v_readfirstlane_b32 s74, v2
  s_nop 0
  s_cmp_ge_u32 s74, s76
  s_cbranch_scc1 L_spun_62
  s_sleep 1
  s_branch L_spin_61
L_spun_62:
  s_cmp_eq_u32 s80, 0
  s_cbranch_scc1 L_noiss_63
  s_lshl_b32 s67, s81, 13
  s_add_u32 s67, s67, s83
  s_mov_b32 m0, s73
  s_nop 0
  buffer_load_dwordx4 v8, s[16:19], s67 offen nt lds
  buffer_load_dwordx4 v9, s[16:19], s67 offen offset:1024 nt lds
  buffer_load_dwordx4 v8, s[16:19], s67 offen offset:2048 nt lds
  buffer_load_dwordx4 v9, s[16:19], s67 offen offset:3072 nt lds
  s_add_u32 s81, s81, 1
  s_and_b32 s81, s81, 15
  s_sub_u32 s80, s80, 1
  s_mov_b32 s82, 1
  s_branch L_iss_64
L_noiss_63:
  s_mov_b32 s82, 0
L_iss_64:
  ds_read_b128 v[224:227], v14 offset:32768
  ds_read_b128 v[228:231], v15 offset:32768
  ds_read_b128 v[232:235], v16 offset:32768
  ds_read_b128 v[236:239], v17 offset:32768
  ds_read_b128 v[240:243], v14 offset:45056
  ds_read_b128 v[244:247], v15 offset:45056
  ds_read_b128 v[248:251], v16 offset:45056
  ds_read_b128 v[252:255], v17 offset:45056
  s_waitcnt lgkmcnt(4)
  v_mfma_f32_16x16x32_bf16 v[200:203], v[224:227], v[136:139], 0
  v_mfma_f32_16x16x32_bf16 v[200:203], v[228:231], v[148:151], v[200:203]
  v_mfma_f32_16x16x32_bf16 v[200:203], v[232:235], v[160:163], v[200:203]
  v_mfma_f32_16x16x32_bf16 v[200:203], v[236:239], v[172:175], v[200:203]
  s_waitcnt lgkmcnt(0)
  v_mfma_f32_16x16x32_bf16 v[212:215], v[240:243], v[136:139], 0
  v_mfma_f32_16x16x32_bf16 v[212:215], v[244:247], v[148:151], v[212:215]
  v_mfma_f32_16x16x32_bf16 v[212:215], v[248:251], v[160:163], v[212:215]
  v_mfma_f32_16x16x32_bf16 v[212:215], v[252:255], v[172:175], v[212:215]
  v_mfma_f32_16x16x32_bf16 v[204:207], v[224:227], v[140:143], 0
  v_mfma_f32_16x16x32_bf16 v[204:207], v[228:231], v[152:155], v[204:207]
  v_mfma_f32_16x16x32_bf16 v[204:207], v[232:235], v[164:167], v[204:207]
  v_mfma_f32_16x16x32_bf16 v[204:207], v[236:239], v[176:179], v[204:207]
  s_cmp_eq_u32 s82, 0
  s_cbranch_scc1 L_v0_65
  s_waitcnt vmcnt(8)
  s_branch L_v8_66
L_v0_65:
  s_waitcnt vmcnt(0)
L_v8_66:
  s_mov_b64 exec, 1
  ds_add_u32 v24, v25 offset:4
  s_mov_b64 exec, -1
  v_mfma_f32_16x16x32_bf16 v[216:219], v[240:243], v[140:143], 0
  v_max3_f32 v32, v200, v201, v202
  v_max3_f32 v35, v203, v212, v213
  v_mfma_f32_16x16x32_bf16 v[216:219], v[244:247], v[152:155], v[216:219]
  v_max3_f32 v32, v32, v214, v215
  v_max_f32 v32, v32, v35
  v_mfma_f32_16x16x32_bf16 v[216:219], v[248:251], v[164:167], v[216:219]
  v_fma_f32 v35, v32, s66, v26
  v_cmp_lt_f32 vcc, s78, v35
  s_cbranch_vccz L_fast_67
  s_call_b64 s[8:9], L_rescale0
L_fast_67:
  v_mfma_f32_16x16x32_bf16 v[216:219], v[252:255], v[176:179], v[216:219]
  v_fma_f32 v200, v200, s66, v26
  v_fma_f32 v201, v201, s66, v26
  v_mfma_f32_16x16x32_bf16 v[208:211], v[224:227], v[144:147], 0
  v_exp_f32 v200, v200
  v_mfma_f32_16x16x32_bf16 v[208:211], v[228:231], v[156:159], v[208:211]
  v_fma_f32 v202, v202, s66, v26
  v_exp_f32 v201, v201
  v_mfma_f32_16x16x32_bf16 v[208:211], v[232:235], v[168:171], v[208:211]
  v_fma_f32 v203, v203, s66, v26
  v_exp_f32 v202, v202
  v_mfma_f32_16x16x32_bf16 v[208:211], v[236:239], v[180:183], v[208:211]
  v_fma_f32 v212, v212, s66, v26
  v_exp_f32 v203, v203
  v_mfma_f32_16x16x32_bf16 v[220:223], v[240:243], v[144:147], 0
  v_fma_f32 v213, v213, s66, v26
  v_exp_f32 v212, v212
  v_mfma_f32_16x16x32_bf16 v[220:223], v[244:247], v[156:159], v[220:223]
  v_fma_f32 v214, v214, s66, v26
  v_exp_f32 v213, v213
  v_mfma_f32_16x16x32_bf16 v[220:223], v[248:251], v[168:171], v[220:223]
  v_fma_f32 v215, v215, s66, v26
  v_exp_f32 v214, v214
  v_mfma_f32_16x16x32_bf16 v[220:223], v[252:255], v[180:183], v[220:223]
  v_add_f32 v32, v200, v201
  v_exp_f32 v215, v215
  ds_read_b64_tr_b16 v[224:225], v18 offset:40960
  ds_read_b64_tr_b16 v[228:229], v19 offset:40960
  ds_read_b64_tr_b16 v[232:233], v20 offset:40960
  ds_read_b64_tr_b16 v[236:237], v21 offset:40960
  ds_read_b64_tr_b16 v[240:241], v6 offset:40960
  ds_read_b64_tr_b16 v[244:245], v7 offset:40960
  ds_read_b64_tr_b16 v[248:249], v38 offset:40960
  ds_read_b64_tr_b16 v[252:253], v39 offset:40960
  ds_read_b64_tr_b16 v[226:227], v18 offset:53248
  ds_read_b64_tr_b16 v[230:231], v19 offset:53248
  ds_read_b64_tr_b16 v[234:235], v20 offset:53248
  ds_read_b64_tr_b16 v[238:239], v21 offset:53248
  ds_read_b64_tr_b16 v[242:243], v6 offset:53248
  ds_read_b64_tr_b16 v[246:247], v7 offset:53248
  ds_read_b64_tr_b16 v[250:251], v38 offset:53248
  ds_read_b64_tr_b16 v[254:255], v39 offset:53248
  v_add_f32 v35, v202, v203
  v_add_f32 v29, v29, v212
  v_add_f32 v32, v32, v213
  v_add_f32 v35, v35, v214
  v_add_f32 v29, v29, v215
  v_cvt_pk_bf16_f32 v200, v200, v201
  v_add_f32 v32, v32, v35
  v_cvt_pk_bf16_f32 v201, v202, v203
  v_cvt_pk_bf16_f32 v202, v212, v213
  v_add_f32 v29, v29, v32
  v_cvt_pk_bf16_f32 v203, v214, v215
  v_max3_f32 v33, v204, v205, v206
  v_max3_f32 v36, v207, v216, v217
  v_max3_f32 v33, v33, v218, v219
  v_max_f32 v33, v33, v36
  v_fma_f32 v36, v33, s66, v27
  v_cmp_lt_f32 vcc, s78, v36
  s_cbranch_vccz L_fast_68
  s_call_b64 s[8:9], L_rescale1
L_fast_68:
  v_fma_f32 v204, v204, s66, v27
  v_fma_f32 v205, v205, s66, v27
  v_exp_f32 v204, v204
  v_fma_f32 v206, v206, s66, v27
  v_exp_f32 v205, v205
  v_fma_f32 v207, v207, s66, v27
  v_exp_f32 v206, v206
  v_fma_f32 v216, v216, s66, v27
  v_exp_f32 v207, v207
  v_fma_f32 v217, v217, s66, v27
  v_exp_f32 v216, v216
  v_fma_f32 v218, v218, s66, v27
  v_exp_f32 v217, v217
  v_fma_f32 v219, v219, s66, v27
  v_exp_f32 v218, v218
  v_add_f32 v33, v204, v205
  v_exp_f32 v219, v219
  v_add_f32 v36, v206, v207
  v_add_f32 v30, v30, v216
  v_add_f32 v33, v33, v217
  v_add_f32 v36, v36, v218
  v_add_f32 v30, v30, v219
  v_cvt_pk_bf16_f32 v204, v204, v205
  v_add_f32 v33, v33, v36
  v_cvt_pk_bf16_f32 v205, v206, v207
  v_cvt_pk_bf16_f32 v206, v216, v217
  v_add_f32 v30, v30, v33
  v_cvt_pk_bf16_f32 v207, v218, v219
  s_waitcnt lgkmcnt(0)
  v_mfma_f32_16x16x32_bf16 v[40:43], v[224:227], v[200:203], v[40:43]
  v_max3_f32 v34, v208, v209, v210
  v_max3_f32 v37, v211, v220, v221
  v_max3_f32 v34, v34, v222, v223
  v_mfma_f32_16x16x32_bf16 v[52:55], v[228:231], v[200:203], v[52:55]
  v_max_f32 v34, v34, v37
  v_fma_f32 v37, v34, s66, v28
  v_cmp_lt_f32 vcc, s78, v37
  s_cbranch_vccz L_fast_69
  s_call_b64 s[8:9], L_rescale2
L_fast_69:
  v_mfma_f32_16x16x32_bf16 v[64:67], v[232:235], v[200:203], v[64:67]
  v_fma_f32 v208, v208, s66, v28
  v_fma_f32 v209, v209, s66, v28
  v_exp_f32 v208, v208
  v_mfma_f32_16x16x32_bf16 v[76:79], v[236:239], v[200:203], v[76:79]
  v_fma_f32 v210, v210, s66, v28
  v_exp_f32 v209, v209
  v_mfma_f32_16x16x32_bf16 v[88:91], v[240:243], v[200:203], v[88:91]
  v_fma_f32 v211, v211, s66, v28
  v_exp_f32 v210, v210
  v_mfma_f32_16x16x32_bf16 v[100:103], v[244:247], v[200:203], v[100:103]
  v_fma_f32 v220, v220, s66, v28
  v_exp_f32 v211, v211
  v_mfma_f32_16x16x32_bf16 v[112:115], v[248:251], v[200:203], v[112:115]
  v_fma_f32 v221, v221, s66, v28
  v_exp_f32 v220, v220
  v_mfma_f32_16x16x32_bf16 v[124:127], v[252:255], v[200:203], v[124:127]
  v_fma_f32 v222, v222, s66, v28
  v_exp_f32 v221, v221
  v_mfma_f32_16x16x32_bf16 v[44:47], v[224:227], v[204:207], v[44:47]
  v_fma_f32 v223, v223, s66, v28
  v_exp_f32 v222, v222
  v_mfma_f32_16x16x32_bf16 v[56:59], v[228:231], v[204:207], v[56:59]
  v_add_f32 v34, v208, v209
  v_exp_f32 v223, v223
  v_mfma_f32_16x16x32_bf16 v[68:71], v[232:235], v[204:207], v[68:71]
  v_add_f32 v37, v210, v211
  v_add_f32 v31, v31, v220
  v_add_f32 v34, v34, v221
  v_mfma_f32_16x16x32_bf16 v[80:83], v[236:239], v[204:207], v[80:83]
  v_add_f32 v37, v37, v222
  v_add_f32 v31, v31, v223
  v_cvt_pk_bf16_f32 v208, v208, v209
  v_mfma_f32_16x16x32_bf16 v[92:95], v[240:243], v[204:207], v[92:95]
  v_add_f32 v34, v34, v37
  v_cvt_pk_bf16_f32 v209, v210, v211
  v_cvt_pk_bf16_f32 v210, v220, v221
  v_mfma_f32_16x16x32_bf16 v[104:107], v[244:247], v[204:207], v[104:107]
  v_add_f32 v31, v31, v34
  v_cvt_pk_bf16_f32 v211, v222, v223
  v_mfma_f32_16x16x32_bf16 v[116:119], v[248:251], v[204:207], v[116:119]
  v_mfma_f32_16x16x32_bf16 v[128:131], v[252:255], v[204:207], v[128:131]
  s_nop 1
  v_mfma_f32_16x16x32_bf16 v[48:51], v[224:227], v[208:211], v[48:51]
  v_mfma_f32_16x16x32_bf16 v[60:63], v[228:231], v[208:211], v[60:63]
  v_mfma_f32_16x16x32_bf16 v[72:75], v[232:235], v[208:211], v[72:75]
  v_mfma_f32_16x16x32_bf16 v[84:87], v[236:239], v[208:211], v[84:87]
  v_mfma_f32_16x16x32_bf16 v[96:99], v[240:243], v[208:211], v[96:99]
  v_mfma_f32_16x16x32_bf16 v[108:111], v[244:247], v[208:211], v[108:111]
  v_mfma_f32_16x16x32_bf16 v[120:123], v[248:251], v[208:211], v[120:123]
  v_mfma_f32_16x16x32_bf16 v[132:135], v[252:255], v[208:211], v[132:135]
  s_add_u32 s76, s76, 4
L_spin_70:
  ds_read_b32 v2, v24 offset:4
  s_waitcnt lgkmcnt(0)
  v_readfirstlane_b32 s74, v2
  s_nop 0
  s_cmp_ge_u32 s74, s76
  s_cbranch_scc1 L_spun_71
  s_sleep 1
  s_branch L_spin_70
L_spun_71:
  s_cmp_eq_u32 s80, 0
  s_cbranch_scc1 L_noiss_72
  s_lshl_b32 s67, s81, 13
  s_add_u32 s67, s67, s83
  s_add_u32 m0, s73, 4096
  s_nop 0
  buffer_load_dwordx4 v8, s[16:19], s67 offen nt lds
  buffer_load_dwordx4 v9, s[16:19], s67 offen offset:1024 nt lds
  buffer_load_dwordx4 v8, s[16:19], s67 offen offset:2048 nt lds
  buffer_load_dwordx4 v9, s[16:19], s67 offen offset:3072 nt lds
  s_add_u32 s81, s81, 1
  s_and_b32 s81, s81, 15
  s_sub_u32 s80, s80, 1
  s_mov_b32 s82, 1
  s_branch L_iss_73
L_noiss_72:
  s_mov_b32 s82, 0
L_iss_73:
  ds_read_b128 v[224:227], v14 offset:36864
  ds_read_b128 v[228:231], v15 offset:36864
  ds_read_b128 v[232:235], v16 offset:36864
  ds_read_b128 v[236:239], v17 offset:36864
  ds_read_b128 v[240:243], v14 offset:49152
  ds_read_b128 v[244:247], v15 offset:49152
  ds_read_b128 v[248:251], v16 offset:49152
  ds_read_b128 v[252:255], v17 offset:49152
  s_waitcnt lgkmcnt(4)
  v_mfma_f32_16x16x32_bf16 v[200:203], v[224:227], v[136:139], 0
  v_mfma_f32_16x16x32_bf16 v[200:203], v[228:231], v[148:151], v[200:203]
  v_mfma_f32_16x16x32_bf16 v[200:203], v[232:235], v[160:163], v[200:203]
  v_mfma_f32_16x16x32_bf16 v[200:203], v[236:239], v[172:175], v[200:203]
  s_waitcnt lgkmcnt(0)
  v_mfma_f32_16x16x32_bf16 v[212:215], v[240:243], v[136:139], 0
  v_mfma_f32_16x16x32_bf16 v[212:215], v[244:247], v[148:151], v[212:215]
  v_mfma_f32_16x16x32_bf16 v[212:215], v[248:251], v[160:163], v[212:215]
  v_mfma_f32_16x16x32_bf16 v[212:215], v[252:255], v[172:175], v[212:215]
  v_mfma_f32_16x16x32_bf16 v[204:207], v[224:227], v[140:143], 0
  v_mfma_f32_16x16x32_bf16 v[204:207], v[228:231], v[152:155], v[204:207]
  v_mfma_f32_16x16x32_bf16 v[204:207], v[232:235], v[164:167], v[204:207]
  v_mfma_f32_16x16x32_bf16 v[204:207], v[236:239], v[176:179], v[204:207]
  s_cmp_eq_u32 s82, 0
  s_cbranch_scc1 L_v0_74
  s_waitcnt vmcnt(8)
  s_branch L_v8_75
L_v0_74:
  s_waitcnt vmcnt(0)
L_v8_75:
  s_mov_b64 exec, 1
  ds_add_u32 v24, v25 offset:4
  s_mov_b64 exec, -1
  v_mfma_f32_16x16x32_bf16 v[216:219], v[240:243], v[140:143], 0
  v_max3_f32 v32, v200, v201, v202
  v_max3_f32 v35, v203, v212, v213
  v_mfma_f32_16x16x32_bf16 v[216:219], v[244:247], v[152:155], v[216:219]
  v_max3_f32 v32, v32, v214, v215
  v_max_f32 v32, v32, v35
  v_mfma_f32_16x16x32_bf16 v[216:219], v[248:251], v[164:167], v[216:219]
  v_fma_f32 v35, v32, s66, v26
  v_cmp_lt_f32 vcc, s78, v35
  s_cbranch_vccz L_fast_76
  s_call_b64 s[8:9], L_rescale0
L_fast_76:
  v_mfma_f32_16x16x32_bf16 v[216:219], v[252:255], v[176:179], v[216:219]
  v_fma_f32 v200, v200, s66, v26
  v_fma_f32 v201, v201, s66, v26
  v_mfma_f32_16x16x32_bf16 v[208:211], v[224:227], v[144:147], 0
  v_exp_f32 v200, v200
  v_mfma_f32_16x16x32_bf16 v[208:211], v[228:231], v[156:159], v[208:211]
  v_fma_f32 v202, v202, s66, v26
  v_exp_f32 v201, v201
  v_mfma_f32_16x16x32_bf16 v[208:211], v[232:235], v[168:171], v[208:211]
  v_fma_f32 v203, v203, s66, v26
  v_exp_f32 v202, v202
  v_mfma_f32_16x16x32_bf16 v[208:211], v[236:239], v[180:183], v[208:211]
  v_fma_f32 v212, v212, s66, v26
  v_exp_f32 v203, v203
  v_mfma_f32_16x16x32_bf16 v[220:223], v[240:243], v[144:147], 0
  v_fma_f32 v213, v213, s66, v26
  v_exp_f32 v212, v212
  v_mfma_f32_16x16x32_bf16 v[220:223], v[244:247], v[156:159], v[220:223]
  v_fma_f32 v214, v214, s66, v26
  v_exp_f32 v213, v213
  v_mfma_f32_16x16x32_bf16 v[220:223], v[248:251], v[168:171], v[220:223]
  v_fma_f32 v215, v215, s66, v26
  v_exp_f32 v214, v214
  v_mfma_f32_16x16x32_bf16 v[220:223], v[252:255], v[180:183], v[220:223]
  v_add_f32 v32, v200, v201
  v_exp_f32 v215, v215
  ds_read_b64_tr_b16 v[224:225], v18 offset:45056
  ds_read_b64_tr_b16 v[228:229], v19 offset:45056
  ds_read_b64_tr_b16 v[232:233], v20 offset:45056
  ds_read_b64_tr_b16 v[236:237], v21 offset:45056
  ds_read_b64_tr_b16 v[240:241], v6 offset:45056
  ds_read_b64_tr_b16 v[244:245], v7 offset:45056
  ds_read_b64_tr_b16 v[248:249], v38 offset:45056
  ds_read_b64_tr_b16 v[252:253], v39 offset:45056
  ds_read_b64_tr_b16 v[226:227], v18 offset:57344
  ds_read_b64_tr_b16 v[230:231], v19 offset:57344
  ds_read_b64_tr_b16 v[234:235], v20 offset:57344
  ds_read_b64_tr_b16 v[238:239], v21 offset:57344
  ds_read_b64_tr_b16 v[242:243], v6 offset:57344
  ds_read_b64_tr_b16 v[246:247], v7 offset:57344
  ds_read_b64_tr_b16 v[250:251], v38 offset:57344
  ds_read_b64_tr_b16 v[254:255], v39 offset:57344
  v_add_f32 v35, v202, v203
  v_add_f32 v29, v29, v212
  v_add_f32 v32, v32, v213
  v_add_f32 v35, v35, v214
  v_add_f32 v29, v29, v215
  v_cvt_pk_bf16_f32 v200, v200, v201
  v_add_f32 v32, v32, v35
  v_cvt_pk_bf16_f32 v201, v202, v203
  v_cvt_pk_bf16_f32 v202, v212, v213
  v_add_f32 v29, v29, v32
  v_cvt_pk_bf16_f32 v203, v214, v215
  v_max3_f32 v33, v204, v205, v206
  v_max3_f32 v36, v207, v216, v217
  v_max3_f32 v33, v33, v218, v219
  v_max_f32 v33, v33, v36
  v_fma_f32 v36, v33, s66, v27
  v_cmp_lt_f32 vcc, s78, v36
  s_cbranch_vccz L_fast_77
  s_call_b64 s[8:9], L_rescale1
L_fast_77:
  v_fma_f32 v204, v204, s66, v27
  v_fma_f32 v205, v205, s66, v27
  v_exp_f32 v204, v204
  v_fma_f32 v206, v206, s66, v27
  v_exp_f32 v205, v205
  v_fma_f32 v207, v207, s66, v27
  v_exp_f32 v206, v206
  v_fma_f32 v216, v216, s66, v27
  v_exp_f32 v207, v207
  v_fma_f32 v217, v217, s66, v27
  v_exp_f32 v216, v216
  v_fma_f32 v218, v218, s66, v27
  v_exp_f32 v217, v217
  v_fma_f32 v219, v219, s66, v27
  v_exp_f32 v218, v218
  v_add_f32 v33, v204, v205
  v_exp_f32 v219, v219
  v_add_f32 v36, v206, v207
  v_add_f32 v30, v30, v216
  v_add_f32 v33, v33, v217
  v_add_f32 v36, v36, v218
  v_add_f32 v30, v30, v219
  v_cvt_pk_bf16_f32 v204, v204, v205
  v_add_f32 v33, v33, v36
  v_cvt_pk_bf16_f32 v205, v206, v207
  v_cvt_pk_bf16_f32 v206, v216, v217
  v_add_f32 v30, v30, v33
  v_cvt_pk_bf16_f32 v207, v218, v219
  s_waitcnt lgkmcnt(0)
  v_mfma_f32_16x16x32_bf16 v[40:43], v[224:227], v[200:203], v[40:43]
  v_max3_f32 v34, v208, v209, v210
  v_max3_f32 v37, v211, v220, v221
  v_max3_f32 v34, v34, v222, v223
  v_mfma_f32_16x16x32_bf16 v[52:55], v[228:231], v[200:203], v[52:55]
  v_max_f32 v34, v34, v37
  v_fma_f32 v37, v34, s66, v28
  v_cmp_lt_f32 vcc, s78, v37
  s_cbranch_vccz L_fast_78
  s_call_b64 s[8:9], L_rescale2
L_fast_78:
  v_mfma_f32_16x16x32_bf16 v[64:67], v[232:235], v[200:203], v[64:67]
  v_fma_f32 v208, v208, s66, v28
  v_fma_f32 v209, v209, s66, v28
  v_exp_f32 v208, v208
  v_mfma_f32_16x16x32_bf16 v[76:79], v[236:239], v[200:203], v[76:79]
  v_fma_f32 v210, v210, s66, v28
  v_exp_f32 v209, v209
  v_mfma_f32_16x16x32_bf16 v[88:91], v[240:243], v[200:203], v[88:91]
  v_fma_f32 v211, v211, s66, v28
  v_exp_f32 v210, v210
  v_mfma_f32_16x16x32_bf16 v[100:103], v[244:247], v[200:203], v[100:103]
  v_fma_f32 v220, v220, s66, v28
  v_exp_f32 v211, v211
  v_mfma_f32_16x16x32_bf16 v[112:115], v[248:251], v[200:203], v[112:115]
  v_fma_f32 v221, v221, s66, v28
  v_exp_f32 v220, v220
  v_mfma_f32_16x16x32_bf16 v[124:127], v[252:255], v[200:203], v[124:127]
  v_fma_f32 v222, v222, s66, v28
  v_exp_f32 v221, v221
  v_mfma_f32_16x16x32_bf16 v[44:47], v[224:227], v[204:207], v[44:47]
  v_fma_f32 v223, v223, s66, v28
  v_exp_f32 v222, v222
  v_mfma_f32_16x16x32_bf16 v[56:59], v[228:231], v[204:207], v[56:59]
  v_add_f32 v34, v208, v209
  v_exp_f32 v223, v223
  v_mfma_f32_16x16x32_bf16 v[68:71], v[232:235], v[204:207], v[68:71]
  v_add_f32 v37, v210, v211
  v_add_f32 v31, v31, v220
  v_add_f32 v34, v34, v221
  v_mfma_f32_16x16x32_bf16 v[80:83], v[236:239], v[204:207], v[80:83]
  v_add_f32 v37, v37, v222
  v_add_f32 v31, v31, v223
  v_cvt_pk_bf16_f32 v208, v208, v209
  v_mfma_f32_16x16x32_bf16 v[92:95], v[240:243], v[204:207], v[92:95]
  v_add_f32 v34, v34, v37
  v_cvt_pk_bf16_f32 v209, v210, v211
  v_cvt_pk_bf16_f32 v210, v220, v221
  v_mfma_f32_16x16x32_bf16 v[104:107], v[244:247], v[204:207], v[104:107]
  v_add_f32 v31, v31, v34
  v_cvt_pk_bf16_f32 v211, v222, v223
  v_mfma_f32_16x16x32_bf16 v[116:119], v[248:251], v[204:207], v[116:119]
  v_mfma_f32_16x16x32_bf16 v[128:131], v[252:255], v[204:207], v[128:131]
  s_nop 1
  v_mfma_f32_16x16x32_bf16 v[48:51], v[224:227], v[208:211], v[48:51]
  v_mfma_f32_16x16x32_bf16 v[60:63], v[228:231], v[208:211], v[60:63]
  v_mfma_f32_16x16x32_bf16 v[72:75], v[232:235], v[208:211], v[72:75]
  v_mfma_f32_16x16x32_bf16 v[84:87], v[236:239], v[208:211], v[84:87]
  v_mfma_f32_16x16x32_bf16 v[96:99], v[240:243], v[208:211], v[96:99]
  v_mfma_f32_16x16x32_bf16 v[108:111], v[244:247], v[208:211], v[108:111]
  v_mfma_f32_16x16x32_bf16 v[120:123], v[248:251], v[208:211], v[120:123]
  v_mfma_f32_16x16x32_bf16 v[132:135], v[252:255], v[208:211], v[132:135]
  s_add_u32 s76, s76, 4
L_spin_79:
  ds_read_b32 v2, v24 offset:4
  s_waitcnt lgkmcnt(0)
  v_readfirstlane_b32 s74, v2
  s_nop 0
  s_cmp_ge_u32 s74, s76
  s_cbranch_scc1 L_spun_80
  s_sleep 1
  s_branch L_spin_79
L_spun_80:
  s_cmp_eq_u32 s80, 0
  s_cbranch_scc1 L_noiss_81
  s_lshl_b32 s67, s81, 13
  s_add_u32 s67, s67, s83
  s_mov_b32 m0, s68
  s_nop 0
  buffer_load_dwordx4 v8, s[16:19], s67 offen nt lds
  buffer_load_dwordx4 v9, s[16:19], s67 offen offset:1024 nt lds
  buffer_load_dwordx4 v8, s[16:19], s67 offen offset:2048 nt lds
  buffer_load_dwordx4 v9, s[16:19], s67 offen offset:3072 nt lds
  s_add_u32 s81, s81, 1
  s_and_b32 s81, s81, 15
  s_sub_u32 s80, s80, 1
  s_mov_b32 s82, 1
  s_branch L_iss_82
L_noiss_81:
  s_mov_b32 s82, 0
L_iss_82:
  ds_read_b128 v[224:227], v14 offset:40960
  ds_read_b128 v[228:231], v15 offset:40960
  ds_read_b128 v[232:235], v16 offset:40960
  ds_read_b128 v[236:239], v17 offset:40960
  ds_read_b128 v[240:243], v14 offset:53248
  ds_read_b128 v[244:247], v15 offset:53248
  ds_read_b128 v[248:251], v16 offset:53248
  ds_read_b128 v[252:255], v17 offset:53248
  s_waitcnt lgkmcnt(4)
  v_mfma_f32_16x16x32_bf16 v[200:203], v[224:227], v[136:139], 0
  v_mfma_f32_16x16x32_bf16 v[200:203], v[228:231], v[148:151], v[200:203]
  v_mfma_f32_16x16x32_bf16 v[200:203], v[232:235], v[160:163], v[200:203]
  v_mfma_f32_16x16x32_bf16 v[200:203], v[236:239], v[172:175], v[200:203]
  s_waitcnt lgkmcnt(0)
  v_mfma_f32_16x16x32_bf16 v[212:215], v[240:243], v[136:139], 0
  v_mfma_f32_16x16x32_bf16 v[212:215], v[244:247], v[148:151], v[212:215]
  v_mfma_f32_16x16x32_bf16 v[212:215], v[248:251], v[160:163], v[212:215]
  v_mfma_f32_16x16x32_bf16 v[212:215], v[252:255], v[172:175], v[212:215]
  v_mfma_f32_16x16x32_bf16 v[204:207], v[224:227], v[140:143], 0
  v_mfma_f32_16x16x32_bf16 v[204:207], v[228:231], v[152:155], v[204:207]
  v_mfma_f32_16x16x32_bf16 v[204:207], v[232:235], v[164:167], v[204:207]
  v_mfma_f32_16x16x32_bf16 v[204:207], v[236:239], v[176:179], v[204:207]
  s_cmp_eq_u32 s82, 0
  s_cbranch_scc1 L_v0_83
  s_waitcnt vmcnt(8)
  s_branch L_v8_84
L_v0_83:
  s_waitcnt vmcnt(0)
L_v8_84:
  s_mov_b64 exec, 1
  ds_add_u32 v24, v25 offset:4
  s_mov_b64 exec, -1
  v_mfma_f32_16x16x32_bf16 v[216:219], v[240:243], v[140:143], 0
  v_max3_f32 v32, v200, v201, v202
  v_max3_f32 v35, v203, v212, v213
  v_mfma_f32_16x16x32_bf16 v[216:219], v[244:247], v[152:155], v[216:219]
  v_max3_f32 v32, v32, v214, v215
  v_max_f32 v32, v32, v35
  v_mfma_f32_16x16x32_bf16 v[216:219], v[248:251], v[164:167], v[216:219]
  v_fma_f32 v35, v32, s66, v26
  v_cmp_lt_f32 vcc, s78, v35
  s_cbranch_vccz L_fast_85
  s_call_b64 s[8:9], L_rescale0
L_fast_85:
  v_mfma_f32_16x16x32_bf16 v[216:219], v[252:255], v[176:179], v[216:219]
  v_fma_f32 v200, v200, s66, v26
  v_fma_f32 v201, v201, s66, v26
  v_mfma_f32_16x16x32_bf16 v[208:211], v[224:227], v[144:147], 0
  v_exp_f32 v200, v200
  v_mfma_f32_16x16x32_bf16 v[208:211], v[228:231], v[156:159], v[208:211]
  v_fma_f32 v202, v202, s66, v26
  v_exp_f32 v201, v201
  v_mfma_f32_16x16x32_bf16 v[208:211], v[232:235], v[168:171], v[208:211]
  v_fma_f32 v203, v203, s66, v26
  v_exp_f32 v202, v202
  v_mfma_f32_16x16x32_bf16 v[208:211], v[236:239], v[180:183], v[208:211]
  v_fma_f32 v212, v212, s66, v26
  v_exp_f32 v203, v203
  v_mfma_f32_16x16x32_bf16 v[220:223], v[240:243], v[144:147], 0
  v_fma_f32 v213, v213, s66, v26
  v_exp_f32 v212, v212
  v_mfma_f32_16x16x32_bf16 v[220:223], v[244:247], v[156:159], v[220:223]
  v_fma_f32 v214, v214, s66, v26
  v_exp_f32 v213, v213
  v_mfma_f32_16x16x32_bf16 v[220:223], v[248:251], v[168:171], v[220:223]
  v_fma_f32 v215, v215, s66, v26
  v_exp_f32 v214, v214
  v_mfma_f32_16x16x32_bf16 v[220:223], v[252:255], v[180:183], v[220:223]
  v_add_f32 v32, v200, v201
  v_exp_f32 v215, v215
  ds_read_b64_tr_b16 v[224:225], v18 offset:49152
  ds_read_b64_tr_b16 v[228:229], v19 offset:49152
  ds_read_b64_tr_b16 v[232:233], v20 offset:49152
  ds_read_b64_tr_b16 v[236:237], v21 offset:49152
  ds_read_b64_tr_b16 v[240:241], v6 offset:49152
  ds_read_b64_tr_b16 v[244:245], v7 offset:49152
  ds_read_b64_tr_b16 v[248:249], v38 offset:49152
  ds_read_b64_tr_b16 v[252:253], v39 offset:49152
  ds_read_b64_tr_b16 v[226:227], v18 offset:61440
  ds_read_b64_tr_b16 v[230:231], v19 offset:61440
  ds_read_b64_tr_b16 v[234:235], v20 offset:61440
  ds_read_b64_tr_b16 v[238:239], v21 offset:61440
  ds_read_b64_tr_b16 v[242:243], v6 offset:61440
  ds_read_b64_tr_b16 v[246:247], v7 offset:61440
  ds_read_b64_tr_b16 v[250:251], v38 offset:61440
  ds_read_b64_tr_b16 v[254:255], v39 offset:61440
  v_add_f32 v35, v202, v203
  v_add_f32 v29, v29, v212
  v_add_f32 v32, v32, v213
  v_add_f32 v35, v35, v214
  v_add_f32 v29, v29, v215
  v_cvt_pk_bf16_f32 v200, v200, v201
  v_add_f32 v32, v32, v35
  v_cvt_pk_bf16_f32 v201, v202, v203
  v_cvt_pk_bf16_f32 v202, v212, v213
  v_add_f32 v29, v29, v32
  v_cvt_pk_bf16_f32 v203, v214, v215
  v_max3_f32 v33, v204, v205, v206
  v_max3_f32 v36, v207, v216, v217
  v_max3_f32 v33, v33, v218, v219
  v_max_f32 v33, v33, v36
  v_fma_f32 v36, v33, s66, v27
  v_cmp_lt_f32 vcc, s78, v36
  s_cbranch_vccz L_fast_86
  s_call_b64 s[8:9], L_rescale1
L_fast_86:
  v_fma_f32 v204, v204, s66, v27
  v_fma_f32 v205, v205, s66, v27
  v_exp_f32 v204, v204
  v_fma_f32 v206, v206, s66, v27
  v_exp_f32 v205, v205
  v_fma_f32 v207, v207, s66, v27
  v_exp_f32 v206, v206
  v_fma_f32 v216, v216, s66, v27
  v_exp_f32 v207, v207
  v_fma_f32 v217, v217, s66, v27
  v_exp_f32 v216, v216
  v_fma_f32 v218, v218, s66, v27
  v_exp_f32 v217, v217
  v_fma_f32 v219, v219, s66, v27
  v_exp_f32 v218, v218
  v_add_f32 v33, v204, v205
  v_exp_f32 v219, v219
  v_add_f32 v36, v206, v207
  v_add_f32 v30, v30, v216
  v_add_f32 v33, v33, v217
  v_add_f32 v36, v36, v218
  v_add_f32 v30, v30, v219
  v_cvt_pk_bf16_f32 v204, v204, v205
  v_add_f32 v33, v33, v36
  v_cvt_pk_bf16_f32 v205, v206, v207
  v_cvt_pk_bf16_f32 v206, v216, v217
  v_add_f32 v30, v30, v33
  v_cvt_pk_bf16_f32 v207, v218, v219
  s_waitcnt lgkmcnt(0)
  v_mfma_f32_16x16x32_bf16 v[40:43], v[224:227], v[200:203], v[40:43]
  v_max3_f32 v34, v208, v209, v210
  v_max3_f32 v37, v211, v220, v221
  v_max3_f32 v34, v34, v222, v223
  v_mfma_f32_16x16x32_bf16 v[52:55], v[228:231], v[200:203], v[52:55]
  v_max_f32 v34, v34, v37
  v_fma_f32 v37, v34, s66, v28
  v_cmp_lt_f32 vcc, s78, v37
  s_cbranch_vccz L_fast_87
  s_call_b64 s[8:9], L_rescale2
L_fast_87:
  v_mfma_f32_16x16x32_bf16 v[64:67], v[232:235], v[200:203], v[64:67]
  v_fma_f32 v208, v208, s66, v28
  v_fma_f32 v209, v209, s66, v28
  v_exp_f32 v208, v208
  v_mfma_f32_16x16x32_bf16 v[76:79], v[236:239], v[200:203], v[76:79]
  v_fma_f32 v210, v210, s66, v28
  v_exp_f32 v209, v209
  v_mfma_f32_16x16x32_bf16 v[88:91], v[240:243], v[200:203], v[88:91]
  v_fma_f32 v211, v211, s66, v28
  v_exp_f32 v210, v210
  v_mfma_f32_16x16x32_bf16 v[100:103], v[244:247], v[200:203], v[100:103]
  v_fma_f32 v220, v220, s66, v28
  v_exp_f32 v211, v211
  v_mfma_f32_16x16x32_bf16 v[112:115], v[248:251], v[200:203], v[112:115]
  v_fma_f32 v221, v221, s66, v28
  v_exp_f32 v220, v220
  v_mfma_f32_16x16x32_bf16 v[124:127], v[252:255], v[200:203], v[124:127]
  v_fma_f32 v222, v222, s66, v28
  v_exp_f32 v221, v221
  v_mfma_f32_16x16x32_bf16 v[44:47], v[224:227], v[204:207], v[44:47]
  v_fma_f32 v223, v223, s66, v28
  v_exp_f32 v222, v222
  v_mfma_f32_16x16x32_bf16 v[56:59], v[228:231], v[204:207], v[56:59]
  v_add_f32 v34, v208, v209
  v_exp_f32 v223, v223
  v_mfma_f32_16x16x32_bf16 v[68:71], v[232:235], v[204:207], v[68:71]
  v_add_f32 v37, v210, v211
  v_add_f32 v31, v31, v220
  v_add_f32 v34, v34, v221
  v_mfma_f32_16x16x32_bf16 v[80:83], v[236:239], v[204:207], v[80:83]
  v_add_f32 v37, v37, v222
  v_add_f32 v31, v31, v223
  v_cvt_pk_bf16_f32 v208, v208, v209
  v_mfma_f32_16x16x32_bf16 v[92:95], v[240:243], v[204:207], v[92:95]
  v_add_f32 v34, v34, v37
  v_cvt_pk_bf16_f32 v209, v210, v211
  v_cvt_pk_bf16_f32 v210, v220, v221
  v_mfma_f32_16x16x32_bf16 v[104:107], v[244:247], v[204:207], v[104:107]
  v_add_f32 v31, v31, v34
  v_cvt_pk_bf16_f32 v211, v222, v223
  v_mfma_f32_16x16x32_bf16 v[116:119], v[248:251], v[204:207], v[116:119]
  v_mfma_f32_16x16x32_bf16 v[128:131], v[252:255], v[204:207], v[128:131]
  s_nop 1
  v_mfma_f32_16x16x32_bf16 v[48:51], v[224:227], v[208:211], v[48:51]
  v_mfma_f32_16x16x32_bf16 v[60:63], v[228:231], v[208:211], v[60:63]
  v_mfma_f32_16x16x32_bf16 v[72:75], v[232:235], v[208:211], v[72:75]
  v_mfma_f32_16x16x32_bf16 v[84:87], v[236:239], v[208:211], v[84:87]
  v_mfma_f32_16x16x32_bf16 v[96:99], v[240:243], v[208:211], v[96:99]
  v_mfma_f32_16x16x32_bf16 v[108:111], v[244:247], v[208:211], v[108:111]
  v_mfma_f32_16x16x32_bf16 v[120:123], v[248:251], v[208:211], v[120:123]
  v_mfma_f32_16x16x32_bf16 v[132:135], v[252:255], v[208:211], v[132:135]
  s_sub_u32 s72, s72, 1
  s_cmp_lg_u32 s72, 0
  s_cbranch_scc1 L_attnA_42
  s_add_u32 s76, s76, 4
L_spin_88:
  ds_read_b32 v2, v24 offset:4
  s_waitcnt lgkmcnt(0)
  v_readfirstlane_b32 s74, v2
  s_nop 0
  s_cmp_ge_u32 s74, s76
  s_cbranch_scc1 L_spun_89
  s_sleep 1
  s_branch L_spin_88
L_spun_89:
  ds_read_b128 v[224:227], v14 offset:0
  ds_read_b128 v[228:231], v15 offset:0
  ds_read_b128 v[232:235], v16 offset:0
  ds_read_b128 v[236:239], v17 offset:0
  ds_read_b128 v[240:243], v14 offset:8192
  ds_read_b128 v[244:247], v15 offset:8192
  ds_read_b128 v[248:251], v16 offset:8192
  ds_read_b128 v[252:255], v17 offset:8192
  s_waitcnt lgkmcnt(4)
  v_mfma_f32_16x16x32_bf16 v[200:203], v[224:227], v[136:139], 0
  v_mfma_f32_16x16x32_bf16 v[200:203], v[228:231], v[148:151], v[200:203]
  v_mfma_f32_16x16x32_bf16 v[200:203], v[232:235], v[160:163], v[200:203]
  v_mfma_f32_16x16x32_bf16 v[200:203], v[236:239], v[172:175], v[200:203]
  s_waitcnt lgkmcnt(0)
  v_mfma_f32_16x16x32_bf16 v[212:215], v[240:243], v[136:139], 0
  v_mfma_f32_16x16x32_bf16 v[212:215], v[244:247], v[148:151], v[212:215]
  v_mfma_f32_16x16x32_bf16 v[212:215], v[248:251], v[160:163], v[212:215]
  v_mfma_f32_16x16x32_bf16 v[212:215], v[252:255], v[172:175], v[212:215]
  v_mfma_f32_16x16x32_bf16 v[204:207], v[224:227], v[140:143], 0
  v_mfma_f32_16x16x32_bf16 v[204:207], v[228:231], v[152:155], v[204:207]
  v_mfma_f32_16x16x32_bf16 v[204:207], v[232:235], v[164:167], v[204:207]
  v_mfma_f32_16x16x32_bf16 v[204:207], v[236:239], v[176:179], v[204:207]
  s_nop 3
  v_mfma_f32_16x16x32_bf16 v[216:219], v[240:243], v[140:143], 0
  v_max3_f32 v32, v200, v201, v202
  v_max3_f32 v35, v203, v212, v213
  v_mfma_f32_16x16x32_bf16 v[216:219], v[244:247], v[152:155], v[216:219]
  v_max3_f32 v32, v32, v214, v215
  v_max_f32 v32, v32, v35
  v_mfma_f32_16x16x32_bf16 v[216:219], v[248:251], v[164:167], v[216:219]
  v_fma_f32 v35, v32, s66, v26
  v_cmp_lt_f32 vcc, s78, v35
  s_cbranch_vccz L_fast_90
  s_call_b64 s[8:9], L_rescale0
L_fast_90:
  v_mfma_f32_16x16x32_bf16 v[216:219], v[252:255], v[176:179], v[216:219]
  v_fma_f32 v200, v200, s66, v26
  v_fma_f32 v201, v201, s66, v26
  v_mfma_f32_16x16x32_bf16 v[208:211], v[224:227], v[144:147], 0
  v_exp_f32 v200, v200
  v_mfma_f32_16x16x32_bf16 v[208:211], v[228:231], v[156:159], v[208:211]
  v_fma_f32 v202, v202, s66, v26
  v_exp_f32 v201, v201
  v_mfma_f32_16x16x32_bf16 v[208:211], v[232:235], v[168:171], v[208:211]
  v_fma_f32 v203, v203, s66, v26
  v_exp_f32 v202, v202
  v_mfma_f32_16x16x32_bf16 v[208:211], v[236:239], v[180:183], v[208:211]
  v_fma_f32 v212, v212, s66, v26
  v_exp_f32 v203, v203
  v_mfma_f32_16x16x32_bf16 v[220:223], v[240:243], v[144:147], 0
  v_fma_f32 v213, v213, s66, v26
  v_exp_f32 v212, v212
  v_mfma_f32_16x16x32_bf16 v[220:223], v[244:247], v[156:159], v[220:223]
  v_fma_f32 v214, v214, s66, v26
  v_exp_f32 v213, v213
  v_mfma_f32_16x16x32_bf16 v[220:223], v[248:251], v[168:171], v[220:223]
  v_fma_f32 v215, v215, s66, v26
  v_exp_f32 v214, v214
  v_mfma_f32_16x16x32_bf16 v[220:223], v[252:255], v[180:183], v[220:223]
  v_add_f32 v32, v200, v201
  v_exp_f32 v215, v215
  ds_read_b64_tr_b16 v[224:225], v18 offset:0
  ds_read_b64_tr_b16 v[228:229], v19 offset:0
  ds_read_b64_tr_b16 v[232:233], v20 offset:0
  ds_read_b64_tr_b16 v[236:237], v21 offset:0
  ds_read_b64_tr_b16 v[240:241], v6 offset:0
  ds_read_b64_tr_b16 v[244:245], v7 offset:0
  ds_read_b64_tr_b16 v[248:249], v38 offset:0
  ds_read_b64_tr_b16 v[252:253], v39 offset:0
  ds_read_b64_tr_b16 v[226:227], v18 offset:8192
  ds_read_b64_tr_b16 v[230:231], v19 offset:8192
  ds_read_b64_tr_b16 v[234:235], v20 offset:8192
  ds_read_b64_tr_b16 v[238:239], v21 offset:8192
  ds_read_b64_tr_b16 v[242:243], v6 offset:8192
  ds_read_b64_tr_b16 v[246:247], v7 offset:8192
  ds_read_b64_tr_b16 v[250:251], v38 offset:8192
  ds_read_b64_tr_b16 v[254:255], v39 offset:8192
  v_add_f32 v35, v202, v203
  v_add_f32 v29, v29, v212
  v_add_f32 v32, v32, v213
  v_add_f32 v35, v35, v214
  v_add_f32 v29, v29, v215
  v_cvt_pk_bf16_f32 v200, v200, v201
  v_add_f32 v32, v32, v35
  v_cvt_pk_bf16_f32 v201, v202, v203
  v_cvt_pk_bf16_f32 v202, v212, v213
  v_add_f32 v29, v29, v32
  v_cvt_pk_bf16_f32 v203, v214, v215
  v_max3_f32 v33, v204, v205, v206
  v_max3_f32 v36, v207, v216, v217
  v_max3_f32 v33, v33, v218, v219
  v_max_f32 v33, v33, v36
  v_fma_f32 v36, v33, s66, v27
  v_cmp_lt_f32 vcc, s78, v36
  s_cbranch_vccz L_fast_91
  s_call_b64 s[8:9], L_rescale1
L_fast_91:
  v_fma_f32 v204, v204, s66, v27
  v_fma_f32 v205, v205, s66, v27
  v_exp_f32 v204, v204
  v_fma_f32 v206, v206, s66, v27
  v_exp_f32 v205, v205
  v_fma_f32 v207, v207, s66, v27
  v_exp_f32 v206, v206
  v_fma_f32 v216, v216, s66, v27
  v_exp_f32 v207, v207
  v_fma_f32 v217, v217, s66, v27
  v_exp_f32 v216, v216
  v_fma_f32 v218, v218, s66, v27
  v_exp_f32 v217, v217
  v_fma_f32 v219, v219, s66, v27
  v_exp_f32 v218, v218
  v_add_f32 v33, v204, v205
  v_exp_f32 v219, v219
  v_add_f32 v36, v206, v207
  v_add_f32 v30, v30, v216
  v_add_f32 v33, v33, v217
  v_add_f32 v36, v36, v218
  v_add_f32 v30, v30, v219
  v_cvt_pk_bf16_f32 v204, v204, v205
  v_add_f32 v33, v33, v36
  v_cvt_pk_bf16_f32 v205, v206, v207
  v_cvt_pk_bf16_f32 v206, v216, v217
  v_add_f32 v30, v30, v33
  v_cvt_pk_bf16_f32 v207, v218, v219
  s_waitcnt lgkmcnt(0)
  v_mfma_f32_16x16x32_bf16 v[40:43], v[224:227], v[200:203], v[40:43]
  v_max3_f32 v34, v208, v209, v210
  v_max3_f32 v37, v211, v220, v221
  v_max3_f32 v34, v34, v222, v223
  v_mfma_f32_16x16x32_bf16 v[52:55], v[228:231], v[200:203], v[52:55]
  v_max_f32 v34, v34, v37
  v_fma_f32 v37, v34, s66, v28
  v_cmp_lt_f32 vcc, s78, v37
  s_cbranch_vccz L_fast_92
  s_call_b64 s[8:9], L_rescale2
L_fast_92:
  v_mfma_f32_16x16x32_bf16 v[64:67], v[232:235], v[200:203], v[64:67]
  v_fma_f32 v208, v208, s66, v28
  v_fma_f32 v209, v209, s66, v28
  v_exp_f32 v208, v208
  v_mfma_f32_16x16x32_bf16 v[76:79], v[236:239], v[200:203], v[76:79]
  v_fma_f32 v210, v210, s66, v28
  v_exp_f32 v209, v209
  v_mfma_f32_16x16x32_bf16 v[88:91], v[240:243], v[200:203], v[88:91]
  v_fma_f32 v211, v211, s66, v28
  v_exp_f32 v210, v210
  v_mfma_f32_16x16x32_bf16 v[100:103], v[244:247], v[200:203], v[100:103]
  v_fma_f32 v220, v220, s66, v28
  v_exp_f32 v211, v211
  v_mfma_f32_16x16x32_bf16 v[112:115], v[248:251], v[200:203], v[112:115]
  v_fma_f32 v221, v221, s66, v28
  v_exp_f32 v220, v220
  v_mfma_f32_16x16x32_bf16 v[124:127], v[252:255], v[200:203], v[124:127]
  v_fma_f32 v222, v222, s66, v28
  v_exp_f32 v221, v221
  v_mfma_f32_16x16x32_bf16 v[44:47], v[224:227], v[204:207], v[44:47]
  v_fma_f32 v223, v223, s66, v28
  v_exp_f32 v222, v222
  v_mfma_f32_16x16x32_bf16 v[56:59], v[228:231], v[204:207], v[56:59]
  v_add_f32 v34, v208, v209
  v_exp_f32 v223, v223
  v_mfma_f32_16x16x32_bf16 v[68:71], v[232:235], v[204:207], v[68:71]
  v_add_f32 v37, v210, v211
  v_add_f32 v31, v31, v220
  v_add_f32 v34, v34, v221
  v_mfma_f32_16x16x32_bf16 v[80:83], v[236:239], v[204:207], v[80:83]
  v_add_f32 v37, v37, v222
  v_add_f32 v31, v31, v223
  v_cvt_pk_bf16_f32 v208, v208, v209
  v_mfma_f32_16x16x32_bf16 v[92:95], v[240:243], v[204:207], v[92:95]
  v_add_f32 v34, v34, v37
  v_cvt_pk_bf16_f32 v209, v210, v211
  v_cvt_pk_bf16_f32 v210, v220, v221
  v_mfma_f32_16x16x32_bf16 v[104:107], v[244:247], v[204:207], v[104:107]
  v_add_f32 v31, v31, v34
  v_cvt_pk_bf16_f32 v211, v222, v223
  v_mfma_f32_16x16x32_bf16 v[116:119], v[248:251], v[204:207], v[116:119]
  v_mfma_f32_16x16x32_bf16 v[128:131], v[252:255], v[204:207], v[128:131]
  s_nop 1
  v_mfma_f32_16x16x32_bf16 v[48:51], v[224:227], v[208:211], v[48:51]
  v_mfma_f32_16x16x32_bf16 v[60:63], v[228:231], v[208:211], v[60:63]
  v_mfma_f32_16x16x32_bf16 v[72:75], v[232:235], v[208:211], v[72:75]
  v_mfma_f32_16x16x32_bf16 v[84:87], v[236:239], v[208:211], v[84:87]
  v_mfma_f32_16x16x32_bf16 v[96:99], v[240:243], v[208:211], v[96:99]
  v_mfma_f32_16x16x32_bf16 v[108:111], v[244:247], v[208:211], v[108:111]
  v_mfma_f32_16x16x32_bf16 v[120:123], v[248:251], v[208:211], v[120:123]
  v_mfma_f32_16x16x32_bf16 v[132:135], v[252:255], v[208:211], v[132:135]
  s_nop 7
  s_setprio 0
  s_mov_b64 exec, 1
  ds_add_u32 v24, v25 offset:4
  s_mov_b64 exec, -1
  s_mov_b64 exec, 1
  ds_add_u32 v24, v25 offset:64
  s_mov_b64 exec, -1
  s_call_b64 s[8:9], L_attn_finish
L_spin_93:
  ds_read_b32 v2, v24 offset:4
  s_waitcnt lgkmcnt(0)
  v_readfirstlane_b32 s74, v2
  s_nop 0
  s_cmp_ge_u32 s74, 72
  s_cbranch_scc1 L_spun_94
  s_sleep 1
  s_branch L_spin_93
L_spun_94:
  s_sub_u32 s75, s73, 16384
  v_add_u32 v18, s75, v18
  v_add_u32 v19, s75, v19
  v_add_u32 v20, s75, v20
  v_add_u32 v21, s75, v21
  v_add_u32 v6, s75, v6
  v_add_u32 v7, s75, v7
  v_add_u32 v38, s75, v38
  v_add_u32 v39, s75, v39
  s_mul_i32 s77, s70, 32768
  s_add_u32 s77, s77, s69
  s_add_u32 s70, s70, 1
  s_and_b32 s70, s70, 15
  s_mov_b32 m0, s73
  s_nop 0
  buffer_load_dwordx4 v10, s[24:27], s77 offen lds
  buffer_load_dwordx4 v11, s[24:27], s77 offen offset:1024 lds
  buffer_load_dwordx4 v12, s[24:27], s77 offen offset:2048 lds
  buffer_load_dwordx4 v13, s[24:27], s77 offen offset:3072 lds
  s_add_u32 s77, s77, 4096
  s_add_u32 m0, s73, 4096
  s_nop 0
  buffer_load_dwordx4 v10, s[24:27], s77 offen lds
  buffer_load_dwordx4 v11, s[24:27], s77 offen offset:1024 lds
  buffer_load_dwordx4 v12, s[24:27], s77 offen offset:2048 lds
  buffer_load_dwordx4 v13, s[24:27], s77 offen offset:3072 lds
  ds_write_b128 v22, v[136:139] offset:0
  ds_write_b128 v22, v[140:143] offset:2048
  ds_write_b128 v22, v[144:147] offset:4096
  ds_write_b128 v5, v[148:151] offset:0
  ds_write_b128 v5, v[152:155] offset:2048
  ds_write_b128 v5, v[156:159] offset:4096
  ds_write_b128 v22, v[160:163] offset:6144
  ds_write_b128 v22, v[164:167] offset:8192
  ds_write_b128 v22, v[168:171] offset:10240
  ds_write_b128 v5, v[172:175] offset:6144
  ds_write_b128 v5, v[176:179] offset:8192
  ds_write_b128 v5, v[180:183] offset:10240
  s_mov_b32 s12, s58
  s_mov_b32 s13, s59
  s_mov_b32 s14, 4194304
  s_mov_b32 s15, 0x20000
  v_lshlrev_b32 v37, 4, v1
  s_lshl_b32 s74, s6, 19
  s_lshl_b32 s75, s5, 14
  s_add_u32 s74, s74, s75
  s_lshl_b32 s75, s4, 12
  s_add_u32 s74, s74, s75
  s_mov_b32 m0, 147712
  s_nop 0
  buffer_load_dwordx4 v37, s[12:15], s74 offen offset:0 lds
  buffer_load_dwordx4 v37, s[12:15], s74 offen offset:1024 lds
  buffer_load_dwordx4 v37, s[12:15], s74 offen offset:2048 lds
  buffer_load_dwordx4 v37, s[12:15], s74 offen offset:3072 lds
  s_waitcnt lgkmcnt(0)
  s_mov_b64 exec, 1
  ds_add_u32 v24, v25 offset:4
  s_mov_b64 exec, -1
L_spin_95:
  ds_read_b32 v2, v24 offset:4
  s_waitcnt lgkmcnt(0)
  v_readfirstlane_b32 s74, v2
  s_nop 0
  s_cmp_ge_u32 s74, 76
  s_cbranch_scc1 L_spun_96
  s_sleep 1
  s_branch L_spin_95
L_spun_96:
  v_mov_b32 v40, 0
  v_mov_b32 v41, 0
  v_mov_b32 v42, 0
  v_mov_b32 v43, 0
  v_mov_b32 v44, 0
  v_mov_b32 v45, 0
  v_mov_b32 v46, 0
  v_mov_b32 v47, 0
  v_mov_b32 v48, 0
  v_mov_b32 v49, 0
  v_mov_b32 v50, 0
  v_mov_b32 v51, 0
  v_mov_b32 v52, 0
  v_mov_b32 v53, 0
  v_mov_b32 v54, 0
  v_mov_b32 v55, 0
  v_mov_b32 v56, 0
  v_mov_b32 v57, 0
  v_mov_b32 v58, 0
  v_mov_b32 v59, 0
  v_mov_b32 v60, 0
  v_mov_b32 v61, 0
  v_mov_b32 v62, 0
  v_mov_b32 v63, 0
  v_mov_b32 v64, 0
  v_mov_b32 v65, 0
  v_mov_b32 v66, 0
  v_mov_b32 v67, 0
  v_mov_b32 v68, 0
  v_mov_b32 v69, 0
  v_mov_b32 v70, 0
  v_mov_b32 v71, 0
  v_mov_b32 v72, 0
  v_mov_b32 v73, 0
  v_mov_b32 v74, 0
  v_mov_b32 v75, 0
  v_mov_b32 v76, 0
  v_mov_b32 v77, 0
  v_mov_b32 v78, 0
  v_mov_b32 v79, 0
  v_mov_b32 v80, 0
  v_mov_b32 v81, 0
  v_mov_b32 v82, 0
  v_mov_b32 v83, 0
  v_mov_b32 v84, 0
  v_mov_b32 v85, 0
  v_mov_b32 v86, 0
  v_mov_b32 v87, 0
  v_mov_b32 v88, 0
  v_mov_b32 v89, 0
  v_mov_b32 v90, 0
  v_mov_b32 v91, 0
  v_mov_b32 v92, 0
  v_mov_b32 v93, 0
  v_mov_b32 v94, 0
  v_mov_b32 v95, 0
  v_mov_b32 v96, 0
  v_mov_b32 v97, 0
  v_mov_b32 v98, 0
  v_mov_b32 v99, 0
  v_mov_b32 v100, 0
  v_mov_b32 v101, 0
  v_mov_b32 v102, 0
  v_mov_b32 v103, 0
  v_mov_b32 v104, 0
  v_mov_b32 v105, 0
  v_mov_b32 v106, 0
  v_mov_b32 v107, 0
  v_mov_b32 v108, 0
  v_mov_b32 v109, 0
  v_mov_b32 v110, 0
  v_mov_b32 v111, 0
  v_mov_b32 v112, 0
  v_mov_b32 v113, 0
  v_mov_b32 v114, 0
  v_mov_b32 v115, 0
  v_mov_b32 v116, 0
  v_mov_b32 v117, 0
  v_mov_b32 v118, 0
  v_mov_b32 v119, 0
  v_mov_b32 v120, 0
  v_mov_b32 v121, 0
  v_mov_b32 v122, 0
  v_mov_b32 v123, 0
  v_mov_b32 v124, 0
  v_mov_b32 v125, 0
  v_mov_b32 v126, 0
  v_mov_b32 v127, 0
  v_mov_b32 v128, 0
  v_mov_b32 v129, 0
  v_mov_b32 v130, 0
  v_mov_b32 v131, 0
  v_mov_b32 v132, 0
  v_mov_b32 v133, 0
  v_mov_b32 v134, 0
  v_mov_b32 v135, 0
  s_and_b32 s74, s71, 1
  s_lshl_b32 s74, s74, 6
  s_lshr_b32 s75, s71, 1
  v_xor_b32 v22, s74, v23
  s_mul_i32 s75, s75, 6144
  v_add_u32 v22, s75, v22
  s_add_u32 s71, s71, 1
  s_and_b32 s71, s71, 15
  s_waitcnt vmcnt(4)
  ds_read_b64_tr_b16 v[136:137], v18
  ds_read_b64_tr_b16 v[140:141], v19
  ds_read_b64_tr_b16 v[144:145], v20
  ds_read_b64_tr_b16 v[148:149], v21
  ds_read_b64_tr_b16 v[152:153], v6
  ds_read_b64_tr_b16 v[156:157], v7
  ds_read_b64_tr_b16 v[160:161], v38
  ds_read_b64_tr_b16 v[164:165], v39
  s_waitcnt lgkmcnt(0)
  s_mul_i32 s77, s70, 32768
  s_add_u32 s77, s77, s69
  s_add_u32 s70, s70, 1
  s_and_b32 s70, s70, 15
  s_mov_b32 m0, s73
  s_nop 0
  buffer_load_dwordx4 v10, s[24:27], s77 offen lds
  buffer_load_dwordx4 v11, s[24:27], s77 offen offset:1024 lds
  buffer_load_dwordx4 v12, s[24:27], s77 offen offset:2048 lds
  buffer_load_dwordx4 v13, s[24:27], s77 offen offset:3072 lds
  s_waitcnt vmcnt(4)
  ds_read_b64_tr_b16 v[138:139], v18 offset:4096
  ds_read_b64_tr_b16 v[142:143], v19 offset:4096
  ds_read_b64_tr_b16 v[146:147], v20 offset:4096
  ds_read_b64_tr_b16 v[150:151], v21 offset:4096
  ds_read_b64_tr_b16 v[154:155], v6 offset:4096
  ds_read_b64_tr_b16 v[158:159], v7 offset:4096
  ds_read_b64_tr_b16 v[162:163], v38 offset:4096
  ds_read_b64_tr_b16 v[166:167], v39 offset:4096
  ds_read_b128 v[200:203], v22 offset:0
  ds_read_b128 v[204:207], v22 offset:2048
  ds_read_b128 v[208:211], v22 offset:4096
  s_waitcnt lgkmcnt(0)
  s_add_u32 s77, s77, 4096
  s_add_u32 m0, s73, 4096
  s_nop 0
  buffer_load_dwordx4 v10, s[24:27], s77 offen lds
  buffer_load_dwordx4 v11, s[24:27], s77 offen offset:1024 lds
  buffer_load_dwordx4 v12, s[24:27], s77 offen offset:2048 lds
  buffer_load_dwordx4 v13, s[24:27], s77 offen offset:3072 lds
  s_and_b32 s74, s71, 1
  s_lshl_b32 s74, s74, 6
  s_lshr_b32 s75, s71, 1
  v_xor_b32 v22, s74, v23
  s_mul_i32 s75, s75, 6144
  v_add_u32 v22, s75, v22
  s_add_u32 s71, s71, 1
  s_and_b32 s71, s71, 15
  s_waitcnt vmcnt(4)
  ds_read_b64_tr_b16 v[168:169], v18
  ds_read_b64_tr_b16 v[172:173], v19
  ds_read_b64_tr_b16 v[176:177], v20
  ds_read_b64_tr_b16 v[180:181], v21
  ds_read_b64_tr_b16 v[184:185], v6
  ds_read_b64_tr_b16 v[188:189], v7
  ds_read_b64_tr_b16 v[192:193], v38
  ds_read_b64_tr_b16 v[196:197], v39
  v_mfma_f32_16x16x32_bf16 v[40:43], v[136:139], v[200:203], v[40:43]
  v_mfma_f32_16x16x32_bf16 v[44:47], v[136:139], v[204:207], v[44:47]
  v_mfma_f32_16x16x32_bf16 v[48:51], v[136:139], v[208:211], v[48:51]
  v_mfma_f32_16x16x32_bf16 v[52:55], v[140:143], v[200:203], v[52:55]
  v_mfma_f32_16x16x32_bf16 v[56:59], v[140:143], v[204:207], v[56:59]
  v_mfma_f32_16x16x32_bf16 v[60:63], v[140:143], v[208:211], v[60:63]
  v_mfma_f32_16x16x32_bf16 v[64:67], v[144:147], v[200:203], v[64:67]
  s_waitcnt lgkmcnt(0)
  s_mul_i32 s77, s70, 32768
  s_add_u32 s77, s77, s69
  s_add_u32 s70, s70, 1
  s_and_b32 s70, s70, 15
  s_mov_b32 m0, s73
  s_nop 0
  buffer_load_dwordx4 v10, s[24:27], s77 offen lds
  buffer_load_dwordx4 v11, s[24:27], s77 offen offset:1024 lds
  buffer_load_dwordx4 v12, s[24:27], s77 offen offset:2048 lds
  buffer_load_dwordx4 v13, s[24:27], s77 offen offset:3072 lds
  s_waitcnt vmcnt(4)
  ds_read_b64_tr_b16 v[170:171], v18 offset:4096
  ds_read_b64_tr_b16 v[174:175], v19 offset:4096
  ds_read_b64_tr_b16 v[178:179], v20 offset:4096
  ds_read_b64_tr_b16 v[182:183], v21 offset:4096
  ds_read_b64_tr_b16 v[186:187], v6 offset:4096
  ds_read_b64_tr_b16 v[190:191], v7 offset:4096
  ds_read_b64_tr_b16 v[194:195], v38 offset:4096
  ds_read_b64_tr_b16 v[198:199], v39 offset:4096
  ds_read_b128 v[212:215], v22 offset:0
  ds_read_b128 v[216:219], v22 offset:2048
  ds_read_b128 v[220:223], v22 offset:4096
  v_mfma_f32_16x16x32_bf16 v[68:71], v[144:147], v[204:207], v[68:71]
  v_mfma_f32_16x16x32_bf16 v[72:75], v[144:147], v[208:211], v[72:75]
  v_mfma_f32_16x16x32_bf16 v[76:79], v[148:151], v[200:203], v[76:79]
  v_mfma_f32_16x16x32_bf16 v[80:83], v[148:151], v[204:207], v[80:83]
  v_mfma_f32_16x16x32_bf16 v[84:87], v[148:151], v[208:211], v[84:87]
  v_mfma_f32_16x16x32_bf16 v[88:91], v[152:155], v[200:203], v[88:91]
  v_mfma_f32_16x16x32_bf16 v[92:95], v[152:155], v[204:207], v[92:95]
  v_mfma_f32_16x16x32_bf16 v[96:99], v[152:155], v[208:211], v[96:99]
  v_mfma_f32_16x16x32_bf16 v[100:103], v[156:159], v[200:203], v[100:103]
  s_waitcnt lgkmcnt(0)
  s_add_u32 s77, s77, 4096
  s_add_u32 m0, s73, 4096
  s_nop 0
  buffer_load_dwordx4 v10, s[24:27], s77 offen lds
  buffer_load_dwordx4 v11, s[24:27], s77 offen offset:1024 lds
  buffer_load_dwordx4 v12, s[24:27], s77 offen offset:2048 lds
  buffer_load_dwordx4 v13, s[24:27], s77 offen offset:3072 lds
  v_mfma_f32_16x16x32_bf16 v[104:107], v[156:159], v[204:207], v[104:107]
  v_mfma_f32_16x16x32_bf16 v[108:111], v[156:159], v[208:211], v[108:111]
  v_mfma_f32_16x16x32_bf16 v[112:115], v[160:163], v[200:203], v[112:115]
  v_mfma_f32_16x16x32_bf16 v[116:119], v[160:163], v[204:207], v[116:119]
  v_mfma_f32_16x16x32_bf16 v[120:123], v[160:163], v[208:211], v[120:123]
  v_mfma_f32_16x16x32_bf16 v[124:127], v[164:167], v[200:203], v[124:127]
  v_mfma_f32_16x16x32_bf16 v[128:131], v[164:167], v[204:207], v[128:131]
  v_mfma_f32_16x16x32_bf16 v[132:135], v[164:167], v[208:211], v[132:135]
  s_mov_b32 s72, 6
L_proj_97:
  s_and_b32 s74, s71, 1
  s_lshl_b32 s74, s74, 6
  s_lshr_b32 s75, s71, 1
  v_xor_b32 v22, s74, v23
  s_mul_i32 s75, s75, 6144
  v_add_u32 v22, s75, v22
  s_add_u32 s71, s71, 1
  s_and_b32 s71, s71, 15
  s_waitcnt vmcnt(4)
  ds_read_b64_tr_b16 v[136:137], v18
  ds_read_b64_tr_b16 v[140:141], v19
  ds_read_b64_tr_b16 v[144:145], v20
  ds_read_b64_tr_b16 v[148:149], v21
  ds_read_b64_tr_b16 v[152:153], v6
  ds_read_b64_tr_b16 v[156:157], v7
  ds_read_b64_tr_b16 v[160:161], v38
  ds_read_b64_tr_b16 v[164:165], v39
  v_mfma_f32_16x16x32_bf16 v[40:43], v[168:171], v[212:215], v[40:43]
  v_mfma_f32_16x16x32_bf16 v[44:47], v[168:171], v[216:219], v[44:47]
  v_mfma_f32_16x16x32_bf16 v[48:51], v[168:171], v[220:223], v[48:51]
  v_mfma_f32_16x16x32_bf16 v[52:55], v[172:175], v[212:215], v[52:55]
  v_mfma_f32_16x16x32_bf16 v[56:59], v[172:175], v[216:219], v[56:59]
  v_mfma_f32_16x16x32_bf16 v[60:63], v[172:175], v[220:223], v[60:63]
  v_mfma_f32_16x16x32_bf16 v[64:67], v[176:179], v[212:215], v[64:67]
  s_waitcnt lgkmcnt(0)
  s_mul_i32 s77, s70, 32768
  s_add_u32 s77, s77, s69
  s_add_u32 s70, s70, 1
  s_and_b32 s70, s70, 15
  s_mov_b32 m0, s73
  s_nop 0
  buffer_load_dwordx4 v10, s[24:27], s77 offen lds
  buffer_load_dwordx4 v11, s[24:27], s77 offen offset:1024 lds
  buffer_load_dwordx4 v12, s[24:27], s77 offen offset:2048 lds
  buffer_load_dwordx4 v13, s[24:27], s77 offen offset:3072 lds
  s_waitcnt vmcnt(4)
  ds_read_b64_tr_b16 v[138:139], v18 offset:4096
  ds_read_b64_tr_b16 v[142:143], v19 offset:4096
  ds_read_b64_tr_b16 v[146:147], v20 offset:4096
  ds_read_b64_tr_b16 v[150:151], v21 offset:4096
  ds_read_b64_tr_b16 v[154:155], v6 offset:4096
  ds_read_b64_tr_b16 v[158:159], v7 offset:4096
  ds_read_b64_tr_b16 v[162:163], v38 offset:4096
  ds_read_b64_tr_b16 v[166:167], v39 offset:4096
  ds_read_b128 v[200:203], v22 offset:0
  ds_read_b128 v[204:207], v22 offset:2048
  ds_read_b128 v[208:211], v22 offset:4096
  v_mfma_f32_16x16x32_bf16 v[68:71], v[176:179], v[216:219], v[68:71]
  v_mfma_f32_16x16x32_bf16 v[72:75], v[176:179], v[220:223], v[72:75]
  v_mfma_f32_16x16x32_bf16 v[76:79], v[180:183], v[212:215], v[76:79]
  v_mfma_f32_16x16x32_bf16 v[80:83], v[180:183], v[216:219], v[80:83]
  v_mfma_f32_16x16x32_bf16 v[84:87], v[180:183], v[220:223], v[84:87]
  v_mfma_f32_16x16x32_bf16 v[88:91], v[184:187], v[212:215], v[88:91]
  v_mfma_f32_16x16x32_bf16 v[92:95], v[184:187], v[216:219], v[92:95]
  v_mfma_f32_16x16x32_bf16 v[96:99], v[184:187], v[220:223], v[96:99]
  v_mfma_f32_16x16x32_bf16 v[100:103], v[188:191], v[212:215], v[100:103]
  s_waitcnt lgkmcnt(0)
  s_add_u32 s77, s77, 4096
  s_add_u32 m0, s73, 4096
  s_nop 0
  buffer_load_dwordx4 v10, s[24:27], s77 offen lds
  buffer_load_dwordx4 v11, s[24:27], s77 offen offset:1024 lds
  buffer_load_dwordx4 v12, s[24:27], s77 offen offset:2048 lds
  buffer_load_dwordx4 v13, s[24:27], s77 offen offset:3072 lds
  v_mfma_f32_16x16x32_bf16 v[104:107], v[188:191], v[216:219], v[104:107]
  v_mfma_f32_16x16x32_bf16 v[108:111], v[188:191], v[220:223], v[108:111]
  v_mfma_f32_16x16x32_bf16 v[112:115], v[192:195], v[212:215], v[112:115]
  v_mfma_f32_16x16x32_bf16 v[116:119], v[192:195], v[216:219], v[116:119]
  v_mfma_f32_16x16x32_bf16 v[120:123], v[192:195], v[220:223], v[120:123]
  v_mfma_f32_16x16x32_bf16 v[124:127], v[196:199], v[212:215], v[124:127]
  v_mfma_f32_16x16x32_bf16 v[128:131], v[196:199], v[216:219], v[128:131]
  v_mfma_f32_16x16x32_bf16 v[132:135], v[196:199], v[220:223], v[132:135]
  s_and_b32 s74, s71, 1
  s_lshl_b32 s74, s74, 6
  s_lshr_b32 s75, s71, 1
  v_xor_b32 v22, s74, v23
  s_mul_i32 s75, s75, 6144
  v_add_u32 v22, s75, v22
  s_add_u32 s71, s71, 1
  s_and_b32 s71, s71, 15
  s_waitcnt vmcnt(4)
  ds_read_b64_tr_b16 v[168:169], v18
  ds_read_b64_tr_b16 v[172:173], v19
  ds_read_b64_tr_b16 v[176:177], v20
  ds_read_b64_tr_b16 v[180:181], v21
  ds_read_b64_tr_b16 v[184:185], v6
  ds_read_b64_tr_b16 v[188:189], v7
  ds_read_b64_tr_b16 v[192:193], v38
  ds_read_b64_tr_b16 v[196:197], v39
  v_mfma_f32_16x16x32_bf16 v[40:43], v[136:139], v[200:203], v[40:43]
  v_mfma_f32_16x16x32_bf16 v[44:47], v[136:139], v[204:207], v[44:47]
  v_mfma_f32_16x16x32_bf16 v[48:51], v[136:139], v[208:211], v[48:51]
  v_mfma_f32_16x16x32_bf16 v[52:55], v[140:143], v[200:203], v[52:55]
  v_mfma_f32_16x16x32_bf16 v[56:59], v[140:143], v[204:207], v[56:59]
  v_mfma_f32_16x16x32_bf16 v[60:63], v[140:143], v[208:211], v[60:63]
  v_mfma_f32_16x16x32_bf16 v[64:67], v[144:147], v[200:203], v[64:67]
  s_waitcnt lgkmcnt(0)
  s_mul_i32 s77, s70, 32768
  s_add_u32 s77, s77, s69
  s_add_u32 s70, s70, 1
  s_and_b32 s70, s70, 15
  s_mov_b32 m0, s73
  s_nop 0
  buffer_load_dwordx4 v10, s[24:27], s77 offen lds
  buffer_load_dwordx4 v11, s[24:27], s77 offen offset:1024 lds
  buffer_load_dwordx4 v12, s[24:27], s77 offen offset:2048 lds
  buffer_load_dwordx4 v13, s[24:27], s77 offen offset:3072 lds
  s_waitcnt vmcnt(4)
  ds_read_b64_tr_b16 v[170:171], v18 offset:4096
  ds_read_b64_tr_b16 v[174:175], v19 offset:4096
  ds_read_b64_tr_b16 v[178:179], v20 offset:4096
  ds_read_b64_tr_b16 v[182:183], v21 offset:4096
  ds_read_b64_tr_b16 v[186:187], v6 offset:4096
  ds_read_b64_tr_b16 v[190:191], v7 offset:4096
  ds_read_b64_tr_b16 v[194:195], v38 offset:4096
  ds_read_b64_tr_b16 v[198:199], v39 offset:4096
  ds_read_b128 v[212:215], v22 offset:0
  ds_read_b128 v[216:219], v22 offset:2048
  ds_read_b128 v[220:223], v22 offset:4096
  v_mfma_f32_16x16x32_bf16 v[68:71], v[144:147], v[204:207], v[68:71]
  v_mfma_f32_16x16x32_bf16 v[72:75], v[144:147], v[208:211], v[72:75]
  v_mfma_f32_16x16x32_bf16 v[76:79], v[148:151], v[200:203], v[76:79]
  v_mfma_f32_16x16x32_bf16 v[80:83], v[148:151], v[204:207], v[80:83]
  v_mfma_f32_16x16x32_bf16 v[84:87], v[148:151], v[208:211], v[84:87]
  v_mfma_f32_16x16x32_bf16 v[88:91], v[152:155], v[200:203], v[88:91]
  v_mfma_f32_16x16x32_bf16 v[92:95], v[152:155], v[204:207], v[92:95]
  v_mfma_f32_16x16x32_bf16 v[96:99], v[152:155], v[208:211], v[96:99]
  v_mfma_f32_16x16x32_bf16 v[100:103], v[156:159], v[200:203], v[100:103]
  s_waitcnt lgkmcnt(0)
  s_add_u32 s77, s77, 4096
  s_add_u32 m0, s73, 4096
  s_nop 0
  buffer_load_dwordx4 v10, s[24:27], s77 offen lds
  buffer_load_dwordx4 v11, s[24:27], s77 offen offset:1024 lds
  buffer_load_dwordx4 v12, s[24:27], s77 offen offset:2048 lds
  buffer_load_dwordx4 v13, s[24:27], s77 offen offset:3072 lds
  v_mfma_f32_16x16x32_bf16 v[104:107], v[156:159], v[204:207], v[104:107]
  v_mfma_f32_16x16x32_bf16 v[108:111], v[156:159], v[208:211], v[108:111]
  v_mfma_f32_16x16x32_bf16 v[112:115], v[160:163], v[200:203], v[112:115]
  v_mfma_f32_16x16x32_bf16 v[116:119], v[160:163], v[204:207], v[116:119]
  v_mfma_f32_16x16x32_bf16 v[120:123], v[160:163], v[208:211], v[120:123]
  v_mfma_f32_16x16x32_bf16 v[124:127], v[164:167], v[200:203], v[124:127]
  v_mfma_f32_16x16x32_bf16 v[128:131], v[164:167], v[204:207], v[128:131]
  v_mfma_f32_16x16x32_bf16 v[132:135], v[164:167], v[208:211], v[132:135]
  s_sub_u32 s72, s72, 1
  s_cmp_lg_u32 s72, 0
  s_cbranch_scc1 L_proj_97
  s_and_b32 s74, s71, 1
  s_lshl_b32 s74, s74, 6
  s_lshr_b32 s75, s71, 1
  v_xor_b32 v22, s74, v23
  s_mul_i32 s75, s75, 6144
  v_add_u32 v22, s75, v22
  s_add_u32 s71, s71, 1
  s_and_b32 s71, s71, 15
  s_waitcnt vmcnt(4)
  ds_read_b64_tr_b16 v[136:137], v18
  ds_read_b64_tr_b16 v[140:141], v19
  ds_read_b64_tr_b16 v[144:145], v20
  ds_read_b64_tr_b16 v[148:149], v21
  ds_read_b64_tr_b16 v[152:153], v6
  ds_read_b64_tr_b16 v[156:157], v7
  ds_read_b64_tr_b16 v[160:161], v38
  ds_read_b64_tr_b16 v[164:165], v39
  v_mfma_f32_16x16x32_bf16 v[40:43], v[168:171], v[212:215], v[40:43]
  v_mfma_f32_16x16x32_bf16 v[44:47], v[168:171], v[216:219], v[44:47]
  v_mfma_f32_16x16x32_bf16 v[48:51], v[168:171], v[220:223], v[48:51]
  v_mfma_f32_16x16x32_bf16 v[52:55], v[172:175], v[212:215], v[52:55]
  v_mfma_f32_16x16x32_bf16 v[56:59], v[172:175], v[216:219], v[56:59]
  v_mfma_f32_16x16x32_bf16 v[60:63], v[172:175], v[220:223], v[60:63]
  v_mfma_f32_16x16x32_bf16 v[64:67], v[176:179], v[212:215], v[64:67]
  s_waitcnt lgkmcnt(0)
  s_mul_i32 s77, s70, 32768
  s_add_u32 s77, s77, s69
  s_add_u32 s70, s70, 1
  s_and_b32 s70, s70, 15
  s_mov_b32 m0, s73
  s_nop 0
  buffer_load_dwordx4 v10, s[24:27], s77 offen lds
  buffer_load_dwordx4 v11, s[24:27], s77 offen offset:1024 lds
  buffer_load_dwordx4 v12, s[24:27], s77 offen offset:2048 lds
  buffer_load_dwordx4 v13, s[24:27], s77 offen offset:3072 lds
  s_waitcnt vmcnt(4)
  ds_read_b64_tr_b16 v[138:139], v18 offset:4096
  ds_read_b64_tr_b16 v[142:143], v19 offset:4096
  ds_read_b64_tr_b16 v[146:147], v20 offset:4096
  ds_read_b64_tr_b16 v[150:151], v21 offset:4096
  ds_read_b64_tr_b16 v[154:155], v6 offset:4096
  ds_read_b64_tr_b16 v[158:159], v7 offset:4096
  ds_read_b64_tr_b16 v[162:163], v38 offset:4096
  ds_read_b64_tr_b16 v[166:167], v39 offset:4096
  ds_read_b128 v[200:203], v22 offset:0
  ds_read_b128 v[204:207], v22 offset:2048
  ds_read_b128 v[208:211], v22 offset:4096
  v_mfma_f32_16x16x32_bf16 v[68:71], v[176:179], v[216:219], v[68:71]
  v_mfma_f32_16x16x32_bf16 v[72:75], v[176:179], v[220:223], v[72:75]
  v_mfma_f32_16x16x32_bf16 v[76:79], v[180:183], v[212:215], v[76:79]
  v_mfma_f32_16x16x32_bf16 v[80:83], v[180:183], v[216:219], v[80:83]
  v_mfma_f32_16x16x32_bf16 v[84:87], v[180:183], v[220:223], v[84:87]
  v_mfma_f32_16x16x32_bf16 v[88:91], v[184:187], v[212:215], v[88:91]
  v_mfma_f32_16x16x32_bf16 v[92:95], v[184:187], v[216:219], v[92:95]
  v_mfma_f32_16x16x32_bf16 v[96:99], v[184:187], v[220:223], v[96:99]
  v_mfma_f32_16x16x32_bf16 v[100:103], v[188:191], v[212:215], v[100:103]
  s_waitcnt lgkmcnt(0)
  s_add_u32 s77, s77, 4096
  s_add_u32 m0, s73, 4096
  s_nop 0
  buffer_load_dwordx4 v10, s[24:27], s77 offen lds
  buffer_load_dwordx4 v11, s[24:27], s77 offen offset:1024 lds
  buffer_load_dwordx4 v12, s[24:27], s77 offen offset:2048 lds
  buffer_load_dwordx4 v13, s[24:27], s77 offen offset:3072 lds
  s_mov_b64 exec, 1
  ds_add_u32 v24, v25 offset:64
  s_mov_b64 exec, -1
  v_mfma_f32_16x16x32_bf16 v[104:107], v[188:191], v[216:219], v[104:107]
  v_mfma_f32_16x16x32_bf16 v[108:111], v[188:191], v[220:223], v[108:111]
  v_mfma_f32_16x16x32_bf16 v[112:115], v[192:195], v[212:215], v[112:115]
  v_mfma_f32_16x16x32_bf16 v[116:119], v[192:195], v[216:219], v[116:119]
  v_mfma_f32_16x16x32_bf16 v[120:123], v[192:195], v[220:223], v[120:123]
  v_mfma_f32_16x16x32_bf16 v[124:127], v[196:199], v[212:215], v[124:127]
  v_mfma_f32_16x16x32_bf16 v[128:131], v[196:199], v[216:219], v[128:131]
  v_mfma_f32_16x16x32_bf16 v[132:135], v[196:199], v[220:223], v[132:135]
  s_and_b32 s74, s71, 1
  s_lshl_b32 s74, s74, 6
  s_lshr_b32 s75, s71, 1
  v_xor_b32 v22, s74, v23
  s_mul_i32 s75, s75, 6144
  v_add_u32 v22, s75, v22
  s_add_u32 s71, s71, 1
  s_and_b32 s71, s71, 15
  s_waitcnt vmcnt(4)
  ds_read_b64_tr_b16 v[168:169], v18
  ds_read_b64_tr_b16 v[172:173], v19
  ds_read_b64_tr_b16 v[176:177], v20
  ds_read_b64_tr_b16 v[180:181], v21
  ds_read_b64_tr_b16 v[184:185], v6
  ds_read_b64_tr_b16 v[188:189], v7
  ds_read_b64_tr_b16 v[192:193], v38
  ds_read_b64_tr_b16 v[196:197], v39
  v_mfma_f32_16x16x32_bf16 v[40:43], v[136:139], v[200:203], v[40:43]
  v_mfma_f32_16x16x32_bf16 v[44:47], v[136:139], v[204:207], v[44:47]
  v_mfma_f32_16x16x32_bf16 v[48:51], v[136:139], v[208:211], v[48:51]
  v_mfma_f32_16x16x32_bf16 v[52:55], v[140:143], v[200:203], v[52:55]
  v_mfma_f32_16x16x32_bf16 v[56:59], v[140:143], v[204:207], v[56:59]
  v_mfma_f32_16x16x32_bf16 v[60:63], v[140:143], v[208:211], v[60:63]
  v_mfma_f32_16x16x32_bf16 v[64:67], v[144:147], v[200:203], v[64:67]
  s_waitcnt vmcnt(0)
  ds_read_b64_tr_b16 v[170:171], v18 offset:4096
  ds_read_b64_tr_b16 v[174:175], v19 offset:4096
  ds_read_b64_tr_b16 v[178:179], v20 offset:4096
  ds_read_b64_tr_b16 v[182:183], v21 offset:4096
  ds_read_b64_tr_b16 v[186:187], v6 offset:4096
  ds_read_b64_tr_b16 v[190:191], v7 offset:4096
  ds_read_b64_tr_b16 v[194:195], v38 offset:4096
  ds_read_b64_tr_b16 v[198:199], v39 offset:4096
  ds_read_b128 v[212:215], v22 offset:0
  ds_read_b128 v[216:219], v22 offset:2048
  ds_read_b128 v[220:223], v22 offset:4096
  v_mfma_f32_16x16x32_bf16 v[68:71], v[144:147], v[204:207], v[68:71]
  v_mfma_f32_16x16x32_bf16 v[72:75], v[144:147], v[208:211], v[72:75]
  v_mfma_f32_16x16x32_bf16 v[76:79], v[148:151], v[200:203], v[76:79]
  v_mfma_f32_16x16x32_bf16 v[80:83], v[148:151], v[204:207], v[80:83]
  v_mfma_f32_16x16x32_bf16 v[84:87], v[148:151], v[208:211], v[84:87]
  v_mfma_f32_16x16x32_bf16 v[88:91], v[152:155], v[200:203], v[88:91]
  v_mfma_f32_16x16x32_bf16 v[92:95], v[152:155], v[204:207], v[92:95]
  v_mfma_f32_16x16x32_bf16 v[96:99], v[152:155], v[208:211], v[96:99]
  v_mfma_f32_16x16x32_bf16 v[100:103], v[156:159], v[200:203], v[100:103]
  s_waitcnt lgkmcnt(0)
  v_mfma_f32_16x16x32_bf16 v[104:107], v[156:159], v[204:207], v[104:107]
  v_mfma_f32_16x16x32_bf16 v[108:111], v[156:159], v[208:211], v[108:111]
  v_mfma_f32_16x16x32_bf16 v[112:115], v[160:163], v[200:203], v[112:115]
  v_mfma_f32_16x16x32_bf16 v[116:119], v[160:163], v[204:207], v[116:119]
  v_mfma_f32_16x16x32_bf16 v[120:123], v[160:163], v[208:211], v[120:123]
  v_mfma_f32_16x16x32_bf16 v[124:127], v[164:167], v[200:203], v[124:127]
  v_mfma_f32_16x16x32_bf16 v[128:131], v[164:167], v[204:207], v[128:131]
  v_mfma_f32_16x16x32_bf16 v[132:135], v[164:167], v[208:211], v[132:135]
  s_mov_b64 exec, 1
  ds_add_u32 v24, v25 offset:4
  s_mov_b64 exec, -1
  v_lshrrev_b32 v2, 5, v1
  v_bfe_u32 v3, v1, 3, 2
  v_lshl_add_u32 v3, v2, 3, v3
  v_lshlrev_b32 v3, 10, v3
  v_and_b32 v4, 7, v1
  v_lshrrev_b32 v2, 4, v1
  v_lshlrev_b32 v2, 1, v2
  v_xor_b32 v4, v4, v2
  v_lshl_add_u32 v10, v4, 4, v3
  v_add_u32 v11, 15360, v10
  v_add_u32 v12, 2048, v10
  v_add_u32 v13, 17408, v10
  s_mov_b32 s24, s58
  s_mov_b32 s25, s59
  s_mov_b32 s26, 4194304
  s_mov_b32 s27, 0x20000
  s_lshl_b32 s69, s6, 19
  s_lshl_b32 s74, s4, 8
  s_add_u32 s69, s69, s74
  s_lshl_b32 s74, s7, 7
  s_add_u32 s69, s69, s74
  s_mov_b32 s70, 0
  s_lshl_b32 s77, s4, 17
  v_lshrrev_b32 v2, 2, v1
  v_and_b32 v3, 3, v1
  v_bfe_u32 v4, v1, 3, 2
  v_lshlrev_b32 v3, 3, v3
  v_lshl_add_u32 v3, v4, 5, v3
  v_lshl_add_u32 v3, v2, 7, v3
  v_add_u32 v18, s73, v3
  v_xor_b32 v4, 32, v3
  v_add_u32 v19, s73, v4
  v_xor_b32 v4, 64, v3
  v_add_u32 v20, s73, v4
  v_xor_b32 v4, 96, v3
  v_add_u32 v21, s73, v4
  s_add_u32 s82, s77, s69
  s_add_u32 m0, s73, 0
  s_add_u32 s77, s77, 0x8000
  buffer_load_dwordx4 v10, s[24:27], s82 offen offset:0 lds
  buffer_load_dwordx4 v11, s[24:27], s82 offen offset:1024 lds
  buffer_load_dwordx4 v12, s[24:27], s82 offen offset:2048 lds
  buffer_load_dwordx4 v13, s[24:27], s82 offen offset:3072 lds
  s_and_b32 s77, s77, 0x7ffff
  s_add_u32 s70, s70, 1
  s_add_u32 s82, s77, s69
  s_add_u32 m0, s73, 4096
  s_add_u32 s77, s77, 0x8000
  buffer_load_dwordx4 v10, s[24:27], s82 offen offset:0 lds
  buffer_load_dwordx4 v11, s[24:27], s82 offen offset:1024 lds
  buffer_load_dwordx4 v12, s[24:27], s82 offen offset:2048 lds
  buffer_load_dwordx4 v13, s[24:27], s82 offen offset:3072 lds
  s_and_b32 s77, s77, 0x7ffff
  s_add_u32 s70, s70, 1
  s_call_b64 s[8:9], L_projend
L_spin_100:
  ds_read_b32 v2, v24 offset:68
  s_waitcnt lgkmcnt(0)
  v_readfirstlane_b32 s74, v2
  s_nop 0
  s_cmp_ge_u32 s74, 56
  s_cbranch_scc1 L_spun_101
  s_sleep 4
  s_branch L_spin_100
L_spun_101:
  v_lshlrev_b32 v37, 4, v1
  s_add_u32 s74, s5, 0
  s_lshl_b32 s74, s74, 3
  s_add_u32 s74, s74, s6
  s_mul_i32 s74, s74, 49152
  s_mul_i32 s75, s4, 12288
  s_add_u32 s74, s74, s75
  buffer_store_dwordx4 v[136:139], v37, s[28:31], s74 offen offset:0 sc1
  buffer_store_dwordx4 v[140:143], v37, s[28:31], s74 offen offset:1024 sc1
  buffer_store_dwordx4 v[144:147], v37, s[28:31], s74 offen offset:2048 sc1
  buffer_store_dwordx4 v[148:151], v37, s[28:31], s74 offen offset:3072 sc1
  s_add_u32 s74, s74, 4096
  buffer_store_dwordx4 v[152:155], v37, s[28:31], s74 offen offset:0 sc1
  buffer_store_dwordx4 v[156:159], v37, s[28:31], s74 offen offset:1024 sc1
  buffer_store_dwordx4 v[160:163], v37, s[28:31], s74 offen offset:2048 sc1
  buffer_store_dwordx4 v[164:167], v37, s[28:31], s74 offen offset:3072 sc1
  s_add_u32 s74, s74, 4096
  buffer_store_dwordx4 v[168:171], v37, s[28:31], s74 offen offset:0 sc1
  buffer_store_dwordx4 v[172:175], v37, s[28:31], s74 offen offset:1024 sc1
  buffer_store_dwordx4 v[176:179], v37, s[28:31], s74 offen offset:2048 sc1
  buffer_store_dwordx4 v[180:183], v37, s[28:31], s74 offen offset:3072 sc1
  s_mov_b32 s79, 0
  s_waitcnt vmcnt(0)
  s_mov_b64 exec, 1
  ds_add_rtn_u32 v2, v24, v25 offset:16
  s_lshl_b32 s75, s79, 5
  s_add_u32 s75, s75, s5
  s_lshl_b32 s75, s75, 8
  s_add_u32 s75, s75, 33554432
  v_mov_b32 v4, s75
  s_lshl_b32 s75, s5, 2
  v_mov_b32 v3, s75
  s_waitcnt lgkmcnt(0)
  v_readfirstlane_b32 s74, v2
  s_nop 0
  s_cmp_lg_u32 s74, 3
  s_cbranch_scc1 L_nosig_102
L_hs_103:
  buffer_load_dword v2, v3, s[36:39], 0 offen sc1
  s_waitcnt vmcnt(0)
  v_readfirstlane_b32 s75, v2
  s_nop 0
  s_cmp_eq_u32 s75, 0
  s_cbranch_scc1 L_hs_103
  buffer_atomic_add v25, v4, s[28:31], 0 offen
  s_waitcnt vmcnt(0)
  ds_add_u32 v24, v25 offset:16
L_nosig_102:
  s_mov_b64 exec, -1
  s_setprio 1
  s_call_b64 s[8:9], L_tail2
  s_setprio 0
L_tail:
L_spin_104:
  ds_read_b32 v2, v24 offset:16
  s_waitcnt lgkmcnt(0)
  v_readfirstlane_b32 s74, v2
  s_nop 0
  s_cmp_ge_u32 s74, 5
  s_cbranch_scc1 L_spun_105
  s_sleep 1
  s_branch L_spin_104
L_spun_105:
  v_lshlrev_b32 v37, 4, v1
  s_add_u32 s74, s5, 32
  s_lshl_b32 s74, s74, 3
  s_add_u32 s74, s74, s6
  s_mul_i32 s74, s74, 49152
  s_mul_i32 s75, s4, 12288
  s_add_u32 s74, s74, s75
  s_mul_i32 s75, s7, 6144
  s_add_u32 s74, s74, s75
  buffer_store_dwordx4 v[136:139], v37, s[28:31], s74 offen offset:0 sc1
  buffer_store_dwordx4 v[140:143], v37, s[28:31], s74 offen offset:1024 sc1
  buffer_store_dwordx4 v[144:147], v37, s[28:31], s74 offen offset:2048 sc1
  buffer_store_dwordx4 v[148:151], v37, s[28:31], s74 offen offset:3072 sc1
  s_add_u32 s74, s74, 4096
  buffer_store_dwordx4 v[152:155], v37, s[28:31], s74 offen offset:0 sc1
  buffer_store_dwordx4 v[156:159], v37, s[28:31], s74 offen offset:1024 sc1
  s_mov_b32 s79, 1
  s_waitcnt vmcnt(0)
  s_mov_b64 exec, 1
  ds_add_rtn_u32 v2, v24, v25 offset:20
  s_lshl_b32 s75, s79, 5
  s_add_u32 s75, s75, s5
  s_lshl_b32 s75, s75, 8
  s_add_u32 s75, s75, 33554432
  v_mov_b32 v4, s75
  s_lshl_b32 s75, s5, 2
  v_mov_b32 v3, s75
  s_waitcnt lgkmcnt(0)
  v_readfirstlane_b32 s74, v2
  s_nop 0
  s_cmp_lg_u32 s74, 7
  s_cbranch_scc1 L_nosig_106
  buffer_atomic_add v25, v4, s[28:31], 0 offen
L_nosig_106:
  s_mov_b64 exec, -1
  s_cmp_eq_u32 s3, 7
  s_cbranch_scc1 L_poller_107
  s_cmp_ge_u32 s3, 6
  s_cbranch_scc1 L_done_108
  s_mul_i32 s80, s6, 6
  s_add_u32 s80, s80, s3
L_spin_109:
  ds_read_b32 v2, v24 offset:24
  s_waitcnt lgkmcnt(0)
  v_readfirstlane_b32 s74, v2
  s_nop 0
  s_cmp_ge_u32 s74, 1
  s_cbranch_scc1 L_spun_110
  s_sleep 1
  s_branch L_spin_109
L_spun_110:
  s_mov_b32 s79, 0
  s_call_b64 s[8:9], L_reduce
L_spin_111:
  ds_read_b32 v2, v24 offset:28
  s_waitcnt lgkmcnt(0)
  v_readfirstlane_b32 s74, v2
  s_nop 0
  s_cmp_ge_u32 s74, 1
  s_cbranch_scc1 L_spun_112
  s_sleep 0
  s_branch L_spin_111
L_spun_112:
  s_mov_b32 s79, 1
  s_call_b64 s[8:9], L_reduce
  s_branch L_done_108
L_poller_107:
  s_mov_b32 s79, 0
  s_lshl_b32 s75, s79, 5
  s_add_u32 s75, s75, s5
  s_lshl_b32 s75, s75, 8
  s_add_u32 s75, s75, 33554432
  v_mov_b32 v3, s75
L_poll_113:
  buffer_load_dword v2, v3, s[28:31], 0 offen sc1
  s_waitcnt vmcnt(0)
  v_readfirstlane_b32 s74, v2
  s_nop 0
  s_cmp_ge_u32 s74, 8
  s_cbranch_scc1 L_polled_114
  s_sleep 1
  s_branch L_poll_113
L_polled_114:
  s_waitcnt lgkmcnt(0)
  s_mov_b64 exec, 1
  ds_add_u32 v24, v25 offset:24
  s_mov_b64 exec, -1
  s_mov_b32 s79, 1
  s_lshl_b32 s75, s79, 5
  s_add_u32 s75, s75, s5
  s_lshl_b32 s75, s75, 8
  s_add_u32 s75, s75, 33554432
  v_mov_b32 v3, s75
L_poll_115:
  buffer_load_dword v2, v3, s[28:31], 0 offen sc1
  s_waitcnt vmcnt(0)
  v_readfirstlane_b32 s74, v2
  s_nop 0
  s_cmp_ge_u32 s74, 8
  s_cbranch_scc1 L_polled_116
  s_sleep 0
  s_branch L_poll_115
L_polled_116:
  s_waitcnt lgkmcnt(0)
  s_mov_b64 exec, 1
  ds_add_u32 v24, v25 offset:28
  s_mov_b64 exec, -1
L_done_108:
L_end:
  s_endpgm
L_tail4:
  v_mov_b32 v40, 0
  v_mov_b32 v41, 0
  v_mov_b32 v42, 0
  v_mov_b32 v43, 0
  v_mov_b32 v44, 0
  v_mov_b32 v45, 0
  v_mov_b32 v46, 0
  v_mov_b32 v47, 0
  v_mov_b32 v48, 0
  v_mov_b32 v49, 0
  v_mov_b32 v50, 0
  v_mov_b32 v51, 0
  v_mov_b32 v52, 0
  v_mov_b32 v53, 0
  v_mov_b32 v54, 0
  v_mov_b32 v55, 0
  v_mov_b32 v56, 0
  v_mov_b32 v57, 0
  v_mov_b32 v58, 0
  v_mov_b32 v59, 0
  v_mov_b32 v60, 0
  v_mov_b32 v61, 0
  v_mov_b32 v62, 0
  v_mov_b32 v63, 0
  v_mov_b32 v64, 0
  v_mov_b32 v65, 0
  v_mov_b32 v66, 0
  v_mov_b32 v67, 0
  v_mov_b32 v68, 0
  v_mov_b32 v69, 0
  v_mov_b32 v70, 0
  v_mov_b32 v71, 0
  v_mov_b32 v72, 0
  v_mov_b32 v73, 0
  v_mov_b32 v74, 0
  v_mov_b32 v75, 0
  v_mov_b32 v76, 0
  v_mov_b32 v77, 0
  v_mov_b32 v78, 0
  v_mov_b32 v79, 0
  v_mov_b32 v80, 0
  v_mov_b32 v81, 0
  v_mov_b32 v82, 0
  v_mov_b32 v83, 0
  v_mov_b32 v84, 0
  v_mov_b32 v85, 0
  v_mov_b32 v86, 0
  v_mov_b32 v87, 0
  s_mov_b32 s71, s4
  s_mov_b32 s72, 0
L_tl_117:
  s_lshl_b32 s74, s71, 2
  v_add_u32 v3, s74, v24
  s_mul_i32 s74, s71, 12288
  v_add_u32 v22, s74, v23
  v_xor_b32 v4, 64, v22
  s_add_u32 s71, s71, 1
  s_and_b32 s71, s71, 3
  s_waitcnt vmcnt(12)
  ds_read_b64_tr_b16 v[136:137], v18 offset:0
  ds_read_b64_tr_b16 v[140:141], v19 offset:0
  ds_read_b64_tr_b16 v[144:145], v20 offset:0
  ds_read_b64_tr_b16 v[148:149], v21 offset:0
  ds_read_b64_tr_b16 v[138:139], v18 offset:2048
  ds_read_b64_tr_b16 v[142:143], v19 offset:2048
  ds_read_b64_tr_b16 v[146:147], v20 offset:2048
  ds_read_b64_tr_b16 v[150:151], v21 offset:2048
  s_cmp_eq_u32 s72, 0
  s_cbranch_scc1 L_sk_118
  v_mfma_f32_16x16x32_bf16 v[40:43], v[168:171], v[212:215], v[40:43]
  v_mfma_f32_16x16x32_bf16 v[44:47], v[168:171], v[216:219], v[44:47]
  v_mfma_f32_16x16x32_bf16 v[48:51], v[168:171], v[220:223], v[48:51]
  v_mfma_f32_16x16x32_bf16 v[52:55], v[172:175], v[212:215], v[52:55]
  v_mfma_f32_16x16x32_bf16 v[56:59], v[172:175], v[216:219], v[56:59]
  v_mfma_f32_16x16x32_bf16 v[60:63], v[172:175], v[220:223], v[60:63]
  v_mfma_f32_16x16x32_bf16 v[64:67], v[176:179], v[212:215], v[64:67]
  v_mfma_f32_16x16x32_bf16 v[68:71], v[176:179], v[216:219], v[68:71]
  v_mfma_f32_16x16x32_bf16 v[72:75], v[176:179], v[220:223], v[72:75]
  v_mfma_f32_16x16x32_bf16 v[76:79], v[180:183], v[212:215], v[76:79]
  v_mfma_f32_16x16x32_bf16 v[80:83], v[180:183], v[216:219], v[80:83]
  v_mfma_f32_16x16x32_bf16 v[84:87], v[180:183], v[220:223], v[84:87]
L_sk_118:
L_spin_119:
  ds_read_b32 v2, v3 offset:80
  s_waitcnt lgkmcnt(0)
  v_readfirstlane_b32 s74, v2
  s_nop 0
  s_cmp_ge_u32 s74, 1
  s_cbranch_scc1 L_spun_120
  s_sleep 1
  s_branch L_spin_119
L_spun_120:
  ds_read_b128 v[200:203], v22 offset:0
  ds_read_b128 v[204:207], v22 offset:2048
  ds_read_b128 v[208:211], v22 offset:4096
  s_cmp_ge_u32 s70, 16
  s_cbranch_scc1 L_ti_121
  s_add_u32 s82, s77, s69
  s_add_u32 m0, s73, 0
  s_add_u32 s77, s77, 0x8000
  buffer_load_dwordx4 v10, s[24:27], s82 offen offset:0 lds
  buffer_load_dwordx4 v11, s[24:27], s82 offen offset:1024 lds
  buffer_load_dwordx4 v12, s[24:27], s82 offen offset:2048 lds
  buffer_load_dwordx4 v13, s[24:27], s82 offen offset:3072 lds
  s_and_b32 s77, s77, 0x7ffff
  s_add_u32 s70, s70, 1
L_ti_121:
  s_waitcnt lgkmcnt(0)
  s_cmp_eq_u32 s72, 3
  s_cbranch_scc1 L_tw_122
  s_waitcnt vmcnt(12)
  s_branch L_tx_123
L_tw_122:
  s_waitcnt vmcnt(8)
L_tx_123:
  v_mfma_f32_16x16x32_bf16 v[40:43], v[136:139], v[200:203], v[40:43]
  ds_read_b64_tr_b16 v[168:169], v18 offset:4096
  ds_read_b64_tr_b16 v[172:173], v19 offset:4096
  v_mfma_f32_16x16x32_bf16 v[44:47], v[136:139], v[204:207], v[44:47]
  ds_read_b64_tr_b16 v[176:177], v20 offset:4096
  ds_read_b64_tr_b16 v[180:181], v21 offset:4096
  v_mfma_f32_16x16x32_bf16 v[48:51], v[136:139], v[208:211], v[48:51]
  ds_read_b64_tr_b16 v[170:171], v18 offset:6144
  ds_read_b64_tr_b16 v[174:175], v19 offset:6144
  v_mfma_f32_16x16x32_bf16 v[52:55], v[140:143], v[200:203], v[52:55]
  ds_read_b64_tr_b16 v[178:179], v20 offset:6144
  ds_read_b64_tr_b16 v[182:183], v21 offset:6144
  v_mfma_f32_16x16x32_bf16 v[56:59], v[140:143], v[204:207], v[56:59]
  ds_read_b128 v[212:215], v4 offset:0
  ds_read_b128 v[216:219], v4 offset:2048
  v_mfma_f32_16x16x32_bf16 v[60:63], v[140:143], v[208:211], v[60:63]
  ds_read_b128 v[220:223], v4 offset:4096
  v_mfma_f32_16x16x32_bf16 v[64:67], v[144:147], v[200:203], v[64:67]
  s_waitcnt lgkmcnt(3)
  s_cmp_ge_u32 s70, 16
  s_cbranch_scc1 L_ti_124
  s_add_u32 s82, s77, s69
  s_add_u32 m0, s73, 4096
  s_add_u32 s77, s77, 0x8000
  buffer_load_dwordx4 v10, s[24:27], s82 offen offset:0 lds
  buffer_load_dwordx4 v11, s[24:27], s82 offen offset:1024 lds
  buffer_load_dwordx4 v12, s[24:27], s82 offen offset:2048 lds
  buffer_load_dwordx4 v13, s[24:27], s82 offen offset:3072 lds
  s_and_b32 s77, s77, 0x7ffff
  s_add_u32 s70, s70, 1
L_ti_124:
  v_mfma_f32_16x16x32_bf16 v[68:71], v[144:147], v[204:207], v[68:71]
  v_mfma_f32_16x16x32_bf16 v[72:75], v[144:147], v[208:211], v[72:75]
  v_mfma_f32_16x16x32_bf16 v[76:79], v[148:151], v[200:203], v[76:79]
  v_mfma_f32_16x16x32_bf16 v[80:83], v[148:151], v[204:207], v[80:83]
  v_mfma_f32_16x16x32_bf16 v[84:87], v[148:151], v[208:211], v[84:87]
  s_waitcnt lgkmcnt(0)
  s_cmp_eq_u32 s72, 3
  s_cbranch_scc1 L_tw_125
  s_waitcnt vmcnt(12)
  s_branch L_tx_126
L_tw_125:
  s_waitcnt vmcnt(4)
L_tx_126:
  v_mfma_f32_16x16x32_bf16 v[40:43], v[168:171], v[212:215], v[40:43]
  ds_read_b64_tr_b16 v[136:137], v18 offset:8192
  ds_read_b64_tr_b16 v[140:141], v19 offset:8192
  v_mfma_f32_16x16x32_bf16 v[44:47], v[168:171], v[216:219], v[44:47]
  ds_read_b64_tr_b16 v[144:145], v20 offset:8192
  ds_read_b64_tr_b16 v[148:149], v21 offset:8192
  v_mfma_f32_16x16x32_bf16 v[48:51], v[168:171], v[220:223], v[48:51]
  ds_read_b64_tr_b16 v[138:139], v18 offset:10240
  ds_read_b64_tr_b16 v[142:143], v19 offset:10240
  v_mfma_f32_16x16x32_bf16 v[52:55], v[172:175], v[212:215], v[52:55]
  ds_read_b64_tr_b16 v[146:147], v20 offset:10240
  ds_read_b64_tr_b16 v[150:151], v21 offset:10240
  v_mfma_f32_16x16x32_bf16 v[56:59], v[172:175], v[216:219], v[56:59]
  ds_read_b128 v[200:203], v22 offset:6144
  ds_read_b128 v[204:207], v22 offset:8192
  v_mfma_f32_16x16x32_bf16 v[60:63], v[172:175], v[220:223], v[60:63]
  ds_read_b128 v[208:211], v22 offset:10240
  v_mfma_f32_16x16x32_bf16 v[64:67], v[176:179], v[212:215], v[64:67]
  s_waitcnt lgkmcnt(3)
  s_cmp_ge_u32 s70, 16
  s_cbranch_scc1 L_ti_127
  s_add_u32 s82, s77, s69
  s_add_u32 m0, s73, 8192
  s_add_u32 s77, s77, 0x8000
  buffer_load_dwordx4 v10, s[24:27], s82 offen offset:0 lds
  buffer_load_dwordx4 v11, s[24:27], s82 offen offset:1024 lds
  buffer_load_dwordx4 v12, s[24:27], s82 offen offset:2048 lds
  buffer_load_dwordx4 v13, s[24:27], s82 offen offset:3072 lds
  s_and_b32 s77, s77, 0x7ffff
  s_add_u32 s70, s70, 1
L_ti_127:
  v_mfma_f32_16x16x32_bf16 v[68:71], v[176:179], v[216:219], v[68:71]
  v_mfma_f32_16x16x32_bf16 v[72:75], v[176:179], v[220:223], v[72:75]
  v_mfma_f32_16x16x32_bf16 v[76:79], v[180:183], v[212:215], v[76:79]
  v_mfma_f32_16x16x32_bf16 v[80:83], v[180:183], v[216:219], v[80:83]
  v_mfma_f32_16x16x32_bf16 v[84:87], v[180:183], v[220:223], v[84:87]
  s_waitcnt lgkmcnt(0)
  s_cmp_eq_u32 s72, 3
  s_cbranch_scc1 L_tw_128
  s_waitcnt vmcnt(12)
  s_branch L_tx_129
L_tw_128:
  s_waitcnt vmcnt(0)
L_tx_129:
  v_mfma_f32_16x16x32_bf16 v[40:43], v[136:139], v[200:203], v[40:43]
  ds_read_b64_tr_b16 v[168:169], v18 offset:12288
  ds_read_b64_tr_b16 v[172:173], v19 offset:12288
  v_mfma_f32_16x16x32_bf16 v[44:47], v[136:139], v[204:207], v[44:47]
  ds_read_b64_tr_b16 v[176:177], v20 offset:12288
  ds_read_b64_tr_b16 v[180:181], v21 offset:12288
  v_mfma_f32_16x16x32_bf16 v[48:51], v[136:139], v[208:211], v[48:51]
  ds_read_b64_tr_b16 v[170:171], v18 offset:14336
  ds_read_b64_tr_b16 v[174:175], v19 offset:14336
  v_mfma_f32_16x16x32_bf16 v[52:55], v[140:143], v[200:203], v[52:55]
  ds_read_b64_tr_b16 v[178:179], v20 offset:14336
  ds_read_b64_tr_b16 v[182:183], v21 offset:14336
  v_mfma_f32_16x16x32_bf16 v[56:59], v[140:143], v[204:207], v[56:59]
  ds_read_b128 v[212:215], v4 offset:6144
  ds_read_b128 v[216:219], v4 offset:8192
  v_mfma_f32_16x16x32_bf16 v[60:63], v[140:143], v[208:211], v[60:63]
  ds_read_b128 v[220:223], v4 offset:10240
  v_mfma_f32_16x16x32_bf16 v[64:67], v[144:147], v[200:203], v[64:67]
  s_waitcnt lgkmcnt(3)
  s_cmp_ge_u32 s70, 16
  s_cbranch_scc1 L_ti_130
  s_add_u32 s82, s77, s69
  s_add_u32 m0, s73, 12288
  s_add_u32 s77, s77, 0x8000
  buffer_load_dwordx4 v10, s[24:27], s82 offen offset:0 lds
  buffer_load_dwordx4 v11, s[24:27], s82 offen offset:1024 lds
  buffer_load_dwordx4 v12, s[24:27], s82 offen offset:2048 lds
  buffer_load_dwordx4 v13, s[24:27], s82 offen offset:3072 lds
  s_and_b32 s77, s77, 0x7ffff
  s_add_u32 s70, s70, 1
L_ti_130:
  v_mfma_f32_16x16x32_bf16 v[68:71], v[144:147], v[204:207], v[68:71]
  v_mfma_f32_16x16x32_bf16 v[72:75], v[144:147], v[208:211], v[72:75]
  v_mfma_f32_16x16x32_bf16 v[76:79], v[148:151], v[200:203], v[76:79]
  v_mfma_f32_16x16x32_bf16 v[80:83], v[148:151], v[204:207], v[80:83]
  v_mfma_f32_16x16x32_bf16 v[84:87], v[148:151], v[208:211], v[84:87]
  s_waitcnt lgkmcnt(0)
  s_add_u32 s72, s72, 1
  s_cmp_lt_u32 s72, 4
  s_cbranch_scc1 L_tl_117
  v_mfma_f32_16x16x32_bf16 v[40:43], v[168:171], v[212:215], v[40:43]
  v_mfma_f32_16x16x32_bf16 v[44:47], v[168:171], v[216:219], v[44:47]
  v_mfma_f32_16x16x32_bf16 v[48:51], v[168:171], v[220:223], v[48:51]
  v_mfma_f32_16x16x32_bf16 v[52:55], v[172:175], v[212:215], v[52:55]
  v_mfma_f32_16x16x32_bf16 v[56:59], v[172:175], v[216:219], v[56:59]
  v_mfma_f32_16x16x32_bf16 v[60:63], v[172:175], v[220:223], v[60:63]
  v_mfma_f32_16x16x32_bf16 v[64:67], v[176:179], v[212:215], v[64:67]
  v_mfma_f32_16x16x32_bf16 v[68:71], v[176:179], v[216:219], v[68:71]
  v_mfma_f32_16x16x32_bf16 v[72:75], v[176:179], v[220:223], v[72:75]
  v_mfma_f32_16x16x32_bf16 v[76:79], v[180:183], v[212:215], v[76:79]
  v_mfma_f32_16x16x32_bf16 v[80:83], v[180:183], v[216:219], v[80:83]
  v_mfma_f32_16x16x32_bf16 v[84:87], v[180:183], v[220:223], v[84:87]
  s_nop 7
  v_cvt_pk_bf16_f32 v136, v40, v41
  v_cvt_pk_bf16_f32 v137, v42, v43
  v_cvt_pk_bf16_f32 v138, v52, v53
  v_cvt_pk_bf16_f32 v139, v54, v55
  v_cvt_pk_bf16_f32 v140, v44, v45
  v_cvt_pk_bf16_f32 v141, v46, v47
  v_cvt_pk_bf16_f32 v142, v56, v57
  v_cvt_pk_bf16_f32 v143, v58, v59
  v_cvt_pk_bf16_f32 v144, v48, v49
  v_cvt_pk_bf16_f32 v145, v50, v51
  v_cvt_pk_bf16_f32 v146, v60, v61
  v_cvt_pk_bf16_f32 v147, v62, v63
  v_cvt_pk_bf16_f32 v148, v64, v65
  v_cvt_pk_bf16_f32 v149, v66, v67
  v_cvt_pk_bf16_f32 v150, v76, v77
  v_cvt_pk_bf16_f32 v151, v78, v79
  v_cvt_pk_bf16_f32 v152, v68, v69
  v_cvt_pk_bf16_f32 v153, v70, v71
  v_cvt_pk_bf16_f32 v154, v80, v81
  v_cvt_pk_bf16_f32 v155, v82, v83
  v_cvt_pk_bf16_f32 v156, v72, v73
  v_cvt_pk_bf16_f32 v157, v74, v75
  v_cvt_pk_bf16_f32 v158, v84, v85
  v_cvt_pk_bf16_f32 v159, v86, v87
  s_nop 1
  v_permlane16_swap_b32 v136, v138
  v_permlane16_swap_b32 v137, v139
  v_permlane16_swap_b32 v140, v142
  v_permlane16_swap_b32 v141, v143
  v_permlane16_swap_b32 v144, v146
  v_permlane16_swap_b32 v145, v147
  v_permlane16_swap_b32 v148, v150
  v_permlane16_swap_b32 v149, v151
  v_permlane16_swap_b32 v152, v154
  v_permlane16_swap_b32 v153, v155
  v_permlane16_swap_b32 v156, v158
  v_permlane16_swap_b32 v157, v159
  s_setpc_b64 s[8:9]
L_tail2:
  v_mov_b32 v40, 0
  v_mov_b32 v41, 0
  v_mov_b32 v42, 0
  v_mov_b32 v43, 0
  v_mov_b32 v44, 0
  v_mov_b32 v45, 0
  v_mov_b32 v46, 0
  v_mov_b32 v47, 0
  v_mov_b32 v48, 0
  v_mov_b32 v49, 0
  v_mov_b32 v50, 0
  v_mov_b32 v51, 0
  v_mov_b32 v52, 0
  v_mov_b32 v53, 0
  v_mov_b32 v54, 0
  v_mov_b32 v55, 0
  v_mov_b32 v56, 0
  v_mov_b32 v57, 0
  v_mov_b32 v58, 0
  v_mov_b32 v59, 0
  v_mov_b32 v60, 0
  v_mov_b32 v61, 0
  v_mov_b32 v62, 0
  v_mov_b32 v63, 0
  v_mov_b32 v64, 0
  v_mov_b32 v65, 0
  v_mov_b32 v66, 0
  v_mov_b32 v67, 0
  v_mov_b32 v68, 0
  v_mov_b32 v69, 0
  v_mov_b32 v70, 0
  v_mov_b32 v71, 0
  v_mov_b32 v72, 0
  v_mov_b32 v73, 0
  v_mov_b32 v74, 0
  v_mov_b32 v75, 0
  v_mov_b32 v76, 0
  v_mov_b32 v77, 0
  v_mov_b32 v78, 0
  v_mov_b32 v79, 0
  v_mov_b32 v80, 0
  v_mov_b32 v81, 0
  v_mov_b32 v82, 0
  v_mov_b32 v83, 0
  v_mov_b32 v84, 0
  v_mov_b32 v85, 0
  v_mov_b32 v86, 0
  v_mov_b32 v87, 0
  s_mov_b32 s71, s4
  s_mov_b32 s72, 0
L_tl_131:
  s_lshl_b32 s74, s71, 2
  v_add_u32 v3, s74, v24
  s_mul_i32 s74, s71, 12288
  v_add_u32 v22, s74, v23
  v_xor_b32 v4, 64, v22
  s_add_u32 s71, s71, 1
  s_and_b32 s71, s71, 3
  s_waitcnt vmcnt(4)
  ds_read_b64_tr_b16 v[136:137], v18 offset:0
  ds_read_b64_tr_b16 v[140:141], v19 offset:0
  ds_read_b64_tr_b16 v[144:145], v20 offset:0
  ds_read_b64_tr_b16 v[148:149], v21 offset:0
  ds_read_b64_tr_b16 v[138:139], v18 offset:2048
  ds_read_b64_tr_b16 v[142:143], v19 offset:2048
  ds_read_b64_tr_b16 v[146:147], v20 offset:2048
  ds_read_b64_tr_b16 v[150:151], v21 offset:2048
  s_cmp_eq_u32 s72, 0
  s_cbranch_scc1 L_sk_132
  v_mfma_f32_16x16x32_bf16 v[40:43], v[168:171], v[212:215], v[40:43]
  v_mfma_f32_16x16x32_bf16 v[44:47], v[168:171], v[216:219], v[44:47]
  v_mfma_f32_16x16x32_bf16 v[48:51], v[168:171], v[220:223], v[48:51]
  v_mfma_f32_16x16x32_bf16 v[52:55], v[172:175], v[212:215], v[52:55]
  v_mfma_f32_16x16x32_bf16 v[56:59], v[172:175], v[216:219], v[56:59]
  v_mfma_f32_16x16x32_bf16 v[60:63], v[172:175], v[220:223], v[60:63]
  v_mfma_f32_16x16x32_bf16 v[64:67], v[176:179], v[212:215], v[64:67]
  v_mfma_f32_16x16x32_bf16 v[68:71], v[176:179], v[216:219], v[68:71]
  v_mfma_f32_16x16x32_bf16 v[72:75], v[176:179], v[220:223], v[72:75]
  v_mfma_f32_16x16x32_bf16 v[76:79], v[180:183], v[212:215], v[76:79]
  v_mfma_f32_16x16x32_bf16 v[80:83], v[180:183], v[216:219], v[80:83]
  v_mfma_f32_16x16x32_bf16 v[84:87], v[180:183], v[220:223], v[84:87]
L_sk_132:
L_spin_133:
  ds_read_b32 v2, v3 offset:80
  s_waitcnt lgkmcnt(0)
  v_readfirstlane_b32 s74, v2
  s_nop 0
  s_cmp_ge_u32 s74, 1
  s_cbranch_scc1 L_spun_134
  s_sleep 1
  s_branch L_spin_133
L_spun_134:
  ds_read_b128 v[200:203], v22 offset:0
  ds_read_b128 v[204:207], v22 offset:2048
  ds_read_b128 v[208:211], v22 offset:4096
  s_cmp_ge_u32 s70, 16
  s_cbranch_scc1 L_ti_135
  s_add_u32 s82, s77, s69
  s_add_u32 m0, s73, 0
  s_add_u32 s77, s77, 0x8000
  buffer_load_dwordx4 v10, s[24:27], s82 offen offset:0 lds
  buffer_load_dwordx4 v11, s[24:27], s82 offen offset:1024 lds
  buffer_load_dwordx4 v12, s[24:27], s82 offen offset:2048 lds
  buffer_load_dwordx4 v13, s[24:27], s82 offen offset:3072 lds
  s_and_b32 s77, s77, 0x7ffff
  s_add_u32 s70, s70, 1
L_ti_135:
  s_waitcnt lgkmcnt(0)
  s_waitcnt vmcnt(4)
  v_mfma_f32_16x16x32_bf16 v[40:43], v[136:139], v[200:203], v[40:43]
  ds_read_b64_tr_b16 v[168:169], v18 offset:4096
  ds_read_b64_tr_b16 v[172:173], v19 offset:4096
  v_mfma_f32_16x16x32_bf16 v[44:47], v[136:139], v[204:207], v[44:47]
  ds_read_b64_tr_b16 v[176:177], v20 offset:4096
  ds_read_b64_tr_b16 v[180:181], v21 offset:4096
  v_mfma_f32_16x16x32_bf16 v[48:51], v[136:139], v[208:211], v[48:51]
  ds_read_b64_tr_b16 v[170:171], v18 offset:6144
  ds_read_b64_tr_b16 v[174:175], v19 offset:6144
  v_mfma_f32_16x16x32_bf16 v[52:55], v[140:143], v[200:203], v[52:55]
  ds_read_b64_tr_b16 v[178:179], v20 offset:6144
  ds_read_b64_tr_b16 v[182:183], v21 offset:6144
  v_mfma_f32_16x16x32_bf16 v[56:59], v[140:143], v[204:207], v[56:59]
  ds_read_b128 v[212:215], v4 offset:0
  ds_read_b128 v[216:219], v4 offset:2048
  v_mfma_f32_16x16x32_bf16 v[60:63], v[140:143], v[208:211], v[60:63]
  ds_read_b128 v[220:223], v4 offset:4096
  v_mfma_f32_16x16x32_bf16 v[64:67], v[144:147], v[200:203], v[64:67]
  s_waitcnt lgkmcnt(3)
  s_cmp_ge_u32 s70, 16
  s_cbranch_scc1 L_ti_136
  s_add_u32 s82, s77, s69
  s_add_u32 m0, s73, 4096
  s_add_u32 s77, s77, 0x8000
  buffer_load_dwordx4 v10, s[24:27], s82 offen offset:0 lds
  buffer_load_dwordx4 v11, s[24:27], s82 offen offset:1024 lds
  buffer_load_dwordx4 v12, s[24:27], s82 offen offset:2048 lds
  buffer_load_dwordx4 v13, s[24:27], s82 offen offset:3072 lds
  s_and_b32 s77, s77, 0x7ffff
  s_add_u32 s70, s70, 1
L_ti_136:
  v_mfma_f32_16x16x32_bf16 v[68:71], v[144:147], v[204:207], v[68:71]
  v_mfma_f32_16x16x32_bf16 v[72:75], v[144:147], v[208:211], v[72:75]
  v_mfma_f32_16x16x32_bf16 v[76:79], v[148:151], v[200:203], v[76:79]
  v_mfma_f32_16x16x32_bf16 v[80:83], v[148:151], v[204:207], v[80:83]
  v_mfma_f32_16x16x32_bf16 v[84:87], v[148:151], v[208:211], v[84:87]
  s_waitcnt lgkmcnt(0)
  s_waitcnt vmcnt(4)
  v_mfma_f32_16x16x32_bf16 v[40:43], v[168:171], v[212:215], v[40:43]
  ds_read_b64_tr_b16 v[136:137], v18 offset:0
  ds_read_b64_tr_b16 v[140:141], v19 offset:0
  v_mfma_f32_16x16x32_bf16 v[44:47], v[168:171], v[216:219], v[44:47]
  ds_read_b64_tr_b16 v[144:145], v20 offset:0
  ds_read_b64_tr_b16 v[148:149], v21 offset:0
  v_mfma_f32_16x16x32_bf16 v[48:51], v[168:171], v[220:223], v[48:51]
  ds_read_b64_tr_b16 v[138:139], v18 offset:2048
  ds_read_b64_tr_b16 v[142:143], v19 offset:2048
  v_mfma_f32_16x16x32_bf16 v[52:55], v[172:175], v[212:215], v[52:55]
  ds_read_b64_tr_b16 v[146:147], v20 offset:2048
  ds_read_b64_tr_b16 v[150:151], v21 offset:2048
  v_mfma_f32_16x16x32_bf16 v[56:59], v[172:175], v[216:219], v[56:59]
  ds_read_b128 v[200:203], v22 offset:6144
  ds_read_b128 v[204:207], v22 offset:8192
  v_mfma_f32_16x16x32_bf16 v[60:63], v[172:175], v[220:223], v[60:63]
  ds_read_b128 v[208:211], v22 offset:10240
  v_mfma_f32_16x16x32_bf16 v[64:67], v[176:179], v[212:215], v[64:67]
  s_waitcnt lgkmcnt(3)
  s_cmp_ge_u32 s70, 16
  s_cbranch_scc1 L_ti_137
  s_add_u32 s82, s77, s69
  s_add_u32 m0, s73, 0
  s_add_u32 s77, s77, 0x8000
  buffer_load_dwordx4 v10, s[24:27], s82 offen offset:0 lds
  buffer_load_dwordx4 v11, s[24:27], s82 offen offset:1024 lds
  buffer_load_dwordx4 v12, s[24:27], s82 offen offset:2048 lds
  buffer_load_dwordx4 v13, s[24:27], s82 offen offset:3072 lds
  s_and_b32 s77, s77, 0x7ffff
  s_add_u32 s70, s70, 1
L_ti_137:
  v_mfma_f32_16x16x32_bf16 v[68:71], v[176:179], v[216:219], v[68:71]
  v_mfma_f32_16x16x32_bf16 v[72:75], v[176:179], v[220:223], v[72:75]
  v_mfma_f32_16x16x32_bf16 v[76:79], v[180:183], v[212:215], v[76:79]
  v_mfma_f32_16x16x32_bf16 v[80:83], v[180:183], v[216:219], v[80:83]
  v_mfma_f32_16x16x32_bf16 v[84:87], v[180:183], v[220:223], v[84:87]
  s_waitcnt lgkmcnt(0)
  s_cmp_eq_u32 s72, 3
  s_cbranch_scc1 L_tw_138
  s_waitcnt vmcnt(4)
  s_branch L_tx_139
L_tw_138:
  s_waitcnt vmcnt(0)
L_tx_139:
  v_mfma_f32_16x16x32_bf16 v[40:43], v[136:139], v[200:203], v[40:43]
  ds_read_b64_tr_b16 v[168:169], v18 offset:4096
  ds_read_b64_tr_b16 v[172:173], v19 offset:4096
  v_mfma_f32_16x16x32_bf16 v[44:47], v[136:139], v[204:207], v[44:47]
  ds_read_b64_tr_b16 v[176:177], v20 offset:4096
  ds_read_b64_tr_b16 v[180:181], v21 offset:4096
  v_mfma_f32_16x16x32_bf16 v[48:51], v[136:139], v[208:211], v[48:51]
  ds_read_b64_tr_b16 v[170:171], v18 offset:6144
  ds_read_b64_tr_b16 v[174:175], v19 offset:6144
  v_mfma_f32_16x16x32_bf16 v[52:55], v[140:143], v[200:203], v[52:55]
  ds_read_b64_tr_b16 v[178:179], v20 offset:6144
  ds_read_b64_tr_b16 v[182:183], v21 offset:6144
  v_mfma_f32_16x16x32_bf16 v[56:59], v[140:143], v[204:207], v[56:59]
  ds_read_b128 v[212:215], v4 offset:6144
  ds_read_b128 v[216:219], v4 offset:8192
  v_mfma_f32_16x16x32_bf16 v[60:63], v[140:143], v[208:211], v[60:63]
  ds_read_b128 v[220:223], v4 offset:10240
  v_mfma_f32_16x16x32_bf16 v[64:67], v[144:147], v[200:203], v[64:67]
  s_waitcnt lgkmcnt(3)
  s_cmp_ge_u32 s70, 16
  s_cbranch_scc1 L_ti_140
  s_add_u32 s82, s77, s69
  s_add_u32 m0, s73, 4096
  s_add_u32 s77, s77, 0x8000
  buffer_load_dwordx4 v10, s[24:27], s82 offen offset:0 lds
  buffer_load_dwordx4 v11, s[24:27], s82 offen offset:1024 lds
  buffer_load_dwordx4 v12, s[24:27], s82 offen offset:2048 lds
  buffer_load_dwordx4 v13, s[24:27], s82 offen offset:3072 lds
  s_and_b32 s77, s77, 0x7ffff
  s_add_u32 s70, s70, 1
L_ti_140:
  v_mfma_f32_16x16x32_bf16 v[68:71], v[144:147], v[204:207], v[68:71]
  v_mfma_f32_16x16x32_bf16 v[72:75], v[144:147], v[208:211], v[72:75]
  v_mfma_f32_16x16x32_bf16 v[76:79], v[148:151], v[200:203], v[76:79]
  v_mfma_f32_16x16x32_bf16 v[80:83], v[148:151], v[204:207], v[80:83]
  v_mfma_f32_16x16x32_bf16 v[84:87], v[148:151], v[208:211], v[84:87]
  s_waitcnt lgkmcnt(0)
  s_add_u32 s72, s72, 1
  s_cmp_lt_u32 s72, 4
  s_cbranch_scc1 L_tl_131
  v_mfma_f32_16x16x32_bf16 v[40:43], v[168:171], v[212:215], v[40:43]
  v_mfma_f32_16x16x32_bf16 v[44:47], v[168:171], v[216:219], v[44:47]
  v_mfma_f32_16x16x32_bf16 v[48:51], v[168:171], v[220:223], v[48:51]
  v_mfma_f32_16x16x32_bf16 v[52:55], v[172:175], v[212:215], v[52:55]
  v_mfma_f32_16x16x32_bf16 v[56:59], v[172:175], v[216:219], v[56:59]
  v_mfma_f32_16x16x32_bf16 v[60:63], v[172:175], v[220:223], v[60:63]
  v_mfma_f32_16x16x32_bf16 v[64:67], v[176:179], v[212:215], v[64:67]
  v_mfma_f32_16x16x32_bf16 v[68:71], v[176:179], v[216:219], v[68:71]
  v_mfma_f32_16x16x32_bf16 v[72:75], v[176:179], v[220:223], v[72:75]
  v_mfma_f32_16x16x32_bf16 v[76:79], v[180:183], v[212:215], v[76:79]
  v_mfma_f32_16x16x32_bf16 v[80:83], v[180:183], v[216:219], v[80:83]
  v_mfma_f32_16x16x32_bf16 v[84:87], v[180:183], v[220:223], v[84:87]
  s_nop 7
  v_cvt_pk_bf16_f32 v136, v40, v41
  v_cvt_pk_bf16_f32 v137, v42, v43
  v_cvt_pk_bf16_f32 v138, v52, v53
  v_cvt_pk_bf16_f32 v139, v54, v55
  v_cvt_pk_bf16_f32 v140, v44, v45
  v_cvt_pk_bf16_f32 v141, v46, v47
  v_cvt_pk_bf16_f32 v142, v56, v57
  v_cvt_pk_bf16_f32 v143, v58, v59
  v_cvt_pk_bf16_f32 v144, v48, v49
  v_cvt_pk_bf16_f32 v145, v50, v51
  v_cvt_pk_bf16_f32 v146, v60, v61
  v_cvt_pk_bf16_f32 v147, v62, v63
  v_cvt_pk_bf16_f32 v148, v64, v65
  v_cvt_pk_bf16_f32 v149, v66, v67
  v_cvt_pk_bf16_f32 v150, v76, v77
  v_cvt_pk_bf16_f32 v151, v78, v79
  v_cvt_pk_bf16_f32 v152, v68, v69
  v_cvt_pk_bf16_f32 v153, v70, v71
  v_cvt_pk_bf16_f32 v154, v80, v81
  v_cvt_pk_bf16_f32 v155, v82, v83
  v_cvt_pk_bf16_f32 v156, v72, v73
  v_cvt_pk_bf16_f32 v157, v74, v75
  v_cvt_pk_bf16_f32 v158, v84, v85
  v_cvt_pk_bf16_f32 v159, v86, v87
  s_nop 1
  v_permlane16_swap_b32 v136, v138
  v_permlane16_swap_b32 v137, v139
  v_permlane16_swap_b32 v140, v142
  v_permlane16_swap_b32 v141, v143
  v_permlane16_swap_b32 v144, v146
  v_permlane16_swap_b32 v145, v147
  v_permlane16_swap_b32 v148, v150
  v_permlane16_swap_b32 v149, v151
  v_permlane16_swap_b32 v152, v154
  v_permlane16_swap_b32 v153, v155
  v_permlane16_swap_b32 v156, v158
  v_permlane16_swap_b32 v157, v159
  s_setpc_b64 s[8:9]
L_rescale0:
  v_mov_b32 v35, v32
  s_nop 1
  v_permlane16_swap_b32 v32, v35
  s_nop 0
  v_max_f32 v32, v32, v35
  v_mov_b32 v35, v32
  s_nop 1
  v_permlane32_swap_b32 v32, v35
  s_nop 0
  v_max_f32 v32, v32, v35
  v_mul_f32 v32, s66, v32
  v_sub_f32 v32, 0, v32
  v_min_f32 v32, v32, v26
  v_sub_f32 v35, v32, v26
  v_mov_b32 v26, v32
  v_exp_f32 v35, v35
  s_nop 0
  v_mul_f32 v29, v35, v29
  v_mul_f32 v40, v35, v40
  v_mul_f32 v41, v35, v41
  v_mul_f32 v42, v35, v42
  v_mul_f32 v43, v35, v43
  v_mul_f32 v52, v35, v52
  v_mul_f32 v53, v35, v53
  v_mul_f32 v54, v35, v54
  v_mul_f32 v55, v35, v55
  v_mul_f32 v64, v35, v64
  v_mul_f32 v65, v35, v65
  v_mul_f32 v66, v35, v66
  v_mul_f32 v67, v35, v67
  v_mul_f32 v76, v35, v76
  v_mul_f32 v77, v35, v77
  v_mul_f32 v78, v35, v78
  v_mul_f32 v79, v35, v79
  v_mul_f32 v88, v35, v88
  v_mul_f32 v89, v35, v89
  v_mul_f32 v90, v35, v90
  v_mul_f32 v91, v35, v91
  v_mul_f32 v100, v35, v100
  v_mul_f32 v101, v35, v101
  v_mul_f32 v102, v35, v102
  v_mul_f32 v103, v35, v103
  v_mul_f32 v112, v35, v112
  v_mul_f32 v113, v35, v113
  v_mul_f32 v114, v35, v114
  v_mul_f32 v115, v35, v115
  v_mul_f32 v124, v35, v124
  v_mul_f32 v125, v35, v125
  v_mul_f32 v126, v35, v126
  v_mul_f32 v127, v35, v127
  s_setpc_b64 s[8:9]
L_rescale1:
  v_mov_b32 v36, v33
  s_nop 1
  v_permlane16_swap_b32 v33, v36
  s_nop 0
  v_max_f32 v33, v33, v36
  v_mov_b32 v36, v33
  s_nop 1
  v_permlane32_swap_b32 v33, v36
  s_nop 0
  v_max_f32 v33, v33, v36
  v_mul_f32 v33, s66, v33
  v_sub_f32 v33, 0, v33
  v_min_f32 v33, v33, v27
  v_sub_f32 v36, v33, v27
  v_mov_b32 v27, v33
  v_exp_f32 v36, v36
  s_nop 0
  v_mul_f32 v30, v36, v30
  v_mul_f32 v44, v36, v44
  v_mul_f32 v45, v36, v45
  v_mul_f32 v46, v36, v46
  v_mul_f32 v47, v36, v47
  v_mul_f32 v56, v36, v56
  v_mul_f32 v57, v36, v57
  v_mul_f32 v58, v36, v58
  v_mul_f32 v59, v36, v59
  v_mul_f32 v68, v36, v68
  v_mul_f32 v69, v36, v69
  v_mul_f32 v70, v36, v70
  v_mul_f32 v71, v36, v71
  v_mul_f32 v80, v36, v80
  v_mul_f32 v81, v36, v81
  v_mul_f32 v82, v36, v82
  v_mul_f32 v83, v36, v83
  v_mul_f32 v92, v36, v92
  v_mul_f32 v93, v36, v93
  v_mul_f32 v94, v36, v94
  v_mul_f32 v95, v36, v95
  v_mul_f32 v104, v36, v104
  v_mul_f32 v105, v36, v105
  v_mul_f32 v106, v36, v106
  v_mul_f32 v107, v36, v107
  v_mul_f32 v116, v36, v116
  v_mul_f32 v117, v36, v117
  v_mul_f32 v118, v36, v118
  v_mul_f32 v119, v36, v119
  v_mul_f32 v128, v36, v128
  v_mul_f32 v129, v36, v129
  v_mul_f32 v130, v36, v130
  v_mul_f32 v131, v36, v131
  s_setpc_b64 s[8:9]
L_rescale2:
  v_mov_b32 v37, v34
  s_nop 1
  v_permlane16_swap_b32 v34, v37
  s_nop 0
  v_max_f32 v34, v34, v37
  v_mov_b32 v37, v34
  s_nop 1
  v_permlane32_swap_b32 v34, v37
  s_nop 0
  v_max_f32 v34, v34, v37
  v_mul_f32 v34, s66, v34
  v_sub_f32 v34, 0, v34
  v_min_f32 v34, v34, v28
  v_sub_f32 v37, v34, v28
  v_mov_b32 v28, v34
  v_exp_f32 v37, v37
  s_nop 0
  v_mul_f32 v31, v37, v31
  v_mul_f32 v48, v37, v48
  v_mul_f32 v49, v37, v49
  v_mul_f32 v50, v37, v50
  v_mul_f32 v51, v37, v51
  v_mul_f32 v60, v37, v60
  v_mul_f32 v61, v37, v61
  v_mul_f32 v62, v37, v62
  v_mul_f32 v63, v37, v63
  v_mul_f32 v72, v37, v72
  v_mul_f32 v73, v37, v73
  v_mul_f32 v74, v37, v74
  v_mul_f32 v75, v37, v75
  v_mul_f32 v84, v37, v84
  v_mul_f32 v85, v37, v85
  v_mul_f32 v86, v37, v86
  v_mul_f32 v87, v37, v87
  v_mul_f32 v96, v37, v96
  v_mul_f32 v97, v37, v97
  v_mul_f32 v98, v37, v98
  v_mul_f32 v99, v37, v99
  v_mul_f32 v108, v37, v108
  v_mul_f32 v109, v37, v109
  v_mul_f32 v110, v37, v110
  v_mul_f32 v111, v37, v111
  v_mul_f32 v120, v37, v120
  v_mul_f32 v121, v37, v121
  v_mul_f32 v122, v37, v122
  v_mul_f32 v123, v37, v123
  v_mul_f32 v132, v37, v132
  v_mul_f32 v133, v37, v133
  v_mul_f32 v134, v37, v134
  v_mul_f32 v135, v37, v135
  s_setpc_b64 s[8:9]
L_attn_zero:
  v_mov_b32 v40, 0
  v_mov_b32 v41, 0
  v_mov_b32 v42, 0
  v_mov_b32 v43, 0
  v_mov_b32 v44, 0
  v_mov_b32 v45, 0
  v_mov_b32 v46, 0
  v_mov_b32 v47, 0
  v_mov_b32 v48, 0
  v_mov_b32 v49, 0
  v_mov_b32 v50, 0
  v_mov_b32 v51, 0
  v_mov_b32 v52, 0
  v_mov_b32 v53, 0
  v_mov_b32 v54, 0
  v_mov_b32 v55, 0
  v_mov_b32 v56, 0
  v_mov_b32 v57, 0
  v_mov_b32 v58, 0
  v_mov_b32 v59, 0
  v_mov_b32 v60, 0
  v_mov_b32 v61, 0
  v_mov_b32 v62, 0
  v_mov_b32 v63, 0
  v_mov_b32 v64, 0
  v_mov_b32 v65, 0
  v_mov_b32 v66, 0
  v_mov_b32 v67, 0
  v_mov_b32 v68, 0
  v_mov_b32 v69, 0
  v_mov_b32 v70, 0
  v_mov_b32 v71, 0
  v_mov_b32 v72, 0
  v_mov_b32 v73, 0
  v_mov_b32 v74, 0
  v_mov_b32 v75, 0
  v_mov_b32 v76, 0
  v_mov_b32 v77, 0
  v_mov_b32 v78, 0
  v_mov_b32 v79, 0
  v_mov_b32 v80, 0
  v_mov_b32 v81, 0
  v_mov_b32 v82, 0
  v_mov_b32 v83, 0
  v_mov_b32 v84, 0
  v_mov_b32 v85, 0
  v_mov_b32 v86, 0
  v_mov_b32 v87, 0
  v_mov_b32 v88, 0
  v_mov_b32 v89, 0
  v_mov_b32 v90, 0
  v_mov_b32 v91, 0
  v_mov_b32 v92, 0
  v_mov_b32 v93, 0
  v_mov_b32 v94, 0
  v_mov_b32 v95, 0
  v_mov_b32 v96, 0
  v_mov_b32 v97, 0
  v_mov_b32 v98, 0
  v_mov_b32 v99, 0
  v_mov_b32 v100, 0
  v_mov_b32 v101, 0
  v_mov_b32 v102, 0
  v_mov_b32 v103, 0
  v_mov_b32 v104, 0
  v_mov_b32 v105, 0
  v_mov_b32 v106, 0
  v_mov_b32 v107, 0
  v_mov_b32 v108, 0
  v_mov_b32 v109, 0
  v_mov_b32 v110, 0
  v_mov_b32 v111, 0
  v_mov_b32 v112, 0
  v_mov_b32 v113, 0
  v_mov_b32 v114, 0
  v_mov_b32 v115, 0
  v_mov_b32 v116, 0
  v_mov_b32 v117, 0
  v_mov_b32 v118, 0
  v_mov_b32 v119, 0
  v_mov_b32 v120, 0
  v_mov_b32 v121, 0
  v_mov_b32 v122, 0
  v_mov_b32 v123, 0
  v_mov_b32 v124, 0
  v_mov_b32 v125, 0
  v_mov_b32 v126, 0
  v_mov_b32 v127, 0
  v_mov_b32 v128, 0
  v_mov_b32 v129, 0
  v_mov_b32 v130, 0
  v_mov_b32 v131, 0
  v_mov_b32 v132, 0
  v_mov_b32 v133, 0
  v_mov_b32 v134, 0
  v_mov_b32 v135, 0
  v_mov_b32 v26, 0x7e000000
  v_mov_b32 v29, 0
  v_mov_b32 v27, 0x7e000000
  v_mov_b32 v30, 0
  v_mov_b32 v28, 0x7e000000
  v_mov_b32 v31, 0
  s_setpc_b64 s[8:9]
L_projend:
  v_mfma_f32_16x16x32_bf16 v[40:43], v[168:171], v[212:215], v[40:43]
  v_mfma_f32_16x16x32_bf16 v[44:47], v[168:171], v[216:219], v[44:47]
  v_mfma_f32_16x16x32_bf16 v[48:51], v[168:171], v[220:223], v[48:51]
  v_mfma_f32_16x16x32_bf16 v[52:55], v[172:175], v[212:215], v[52:55]
  v_mfma_f32_16x16x32_bf16 v[56:59], v[172:175], v[216:219], v[56:59]
  v_mfma_f32_16x16x32_bf16 v[60:63], v[172:175], v[220:223], v[60:63]
  v_mfma_f32_16x16x32_bf16 v[64:67], v[176:179], v[212:215], v[64:67]
  v_mfma_f32_16x16x32_bf16 v[68:71], v[176:179], v[216:219], v[68:71]
  v_mfma_f32_16x16x32_bf16 v[72:75], v[176:179], v[220:223], v[72:75]
  v_mfma_f32_16x16x32_bf16 v[76:79], v[180:183], v[212:215], v[76:79]
  v_mfma_f32_16x16x32_bf16 v[80:83], v[180:183], v[216:219], v[80:83]
  v_mfma_f32_16x16x32_bf16 v[84:87], v[180:183], v[220:223], v[84:87]
  v_mfma_f32_16x16x32_bf16 v[88:91], v[184:187], v[212:215], v[88:91]
  v_mfma_f32_16x16x32_bf16 v[92:95], v[184:187], v[216:219], v[92:95]
  v_mfma_f32_16x16x32_bf16 v[96:99], v[184:187], v[220:223], v[96:99]
  v_mfma_f32_16x16x32_bf16 v[100:103], v[188:191], v[212:215], v[100:103]
  v_mfma_f32_16x16x32_bf16 v[104:107], v[188:191], v[216:219], v[104:107]
  v_mfma_f32_16x16x32_bf16 v[108:111], v[188:191], v[220:223], v[108:111]
  v_mfma_f32_16x16x32_bf16 v[112:115], v[192:195], v[212:215], v[112:115]
  v_mfma_f32_16x16x32_bf16 v[116:119], v[192:195], v[216:219], v[116:119]
  v_mfma_f32_16x16x32_bf16 v[120:123], v[192:195], v[220:223], v[120:123]
  v_mfma_f32_16x16x32_bf16 v[124:127], v[196:199], v[212:215], v[124:127]
  v_mfma_f32_16x16x32_bf16 v[128:131], v[196:199], v[216:219], v[128:131]
  v_mfma_f32_16x16x32_bf16 v[132:135], v[196:199], v[220:223], v[132:135]
  s_nop 7
  v_cvt_pk_bf16_f32 v136, v40, v41
  v_cvt_pk_bf16_f32 v137, v42, v43
  v_cvt_pk_bf16_f32 v138, v52, v53
  v_cvt_pk_bf16_f32 v139, v54, v55
  v_cvt_pk_bf16_f32 v140, v44, v45
  v_cvt_pk_bf16_f32 v141, v46, v47
  v_cvt_pk_bf16_f32 v142, v56, v57
  v_cvt_pk_bf16_f32 v143, v58, v59
  v_cvt_pk_bf16_f32 v144, v48, v49
  v_cvt_pk_bf16_f32 v145, v50, v51
  v_cvt_pk_bf16_f32 v146, v60, v61
  v_cvt_pk_bf16_f32 v147, v62, v63
  v_cvt_pk_bf16_f32 v148, v64, v65
  v_cvt_pk_bf16_f32 v149, v66, v67
  v_cvt_pk_bf16_f32 v150, v76, v77
  v_cvt_pk_bf16_f32 v151, v78, v79
  v_cvt_pk_bf16_f32 v152, v68, v69
  v_cvt_pk_bf16_f32 v153, v70, v71
  v_cvt_pk_bf16_f32 v154, v80, v81
  v_cvt_pk_bf16_f32 v155, v82, v83
  v_cvt_pk_bf16_f32 v156, v72, v73
  v_cvt_pk_bf16_f32 v157, v74, v75
  v_cvt_pk_bf16_f32 v158, v84, v85
  v_cvt_pk_bf16_f32 v159, v86, v87
  v_cvt_pk_bf16_f32 v160, v88, v89
  v_cvt_pk_bf16_f32 v161, v90, v91
  v_cvt_pk_bf16_f32 v162, v100, v101
  v_cvt_pk_bf16_f32 v163, v102, v103
  v_cvt_pk_bf16_f32 v164, v92, v93
  v_cvt_pk_bf16_f32 v165, v94, v95
  v_cvt_pk_bf16_f32 v166, v104, v105
  v_cvt_pk_bf16_f32 v167, v106, v107
  v_cvt_pk_bf16_f32 v168, v96, v97
  v_cvt_pk_bf16_f32 v169, v98, v99
  v_cvt_pk_bf16_f32 v170, v108, v109
  v_cvt_pk_bf16_f32 v171, v110, v111
  v_cvt_pk_bf16_f32 v172, v112, v113
  v_cvt_pk_bf16_f32 v173, v114, v115
  v_cvt_pk_bf16_f32 v174, v124, v125
  v_cvt_pk_bf16_f32 v175, v126, v127
  v_cvt_pk_bf16_f32 v176, v116, v117
  v_cvt_pk_bf16_f32 v177, v118, v119
  v_cvt_pk_bf16_f32 v178, v128, v129
  v_cvt_pk_bf16_f32 v179, v130, v131
  v_cvt_pk_bf16_f32 v180, v120, v121
  v_cvt_pk_bf16_f32 v181, v122, v123
  v_cvt_pk_bf16_f32 v182, v132, v133
  v_cvt_pk_bf16_f32 v183, v134, v135
  s_nop 1
  v_permlane16_swap_b32 v136, v138
  v_permlane16_swap_b32 v137, v139
  v_permlane16_swap_b32 v140, v142
  v_permlane16_swap_b32 v141, v143
  v_permlane16_swap_b32 v144, v146
  v_permlane16_swap_b32 v145, v147
  v_permlane16_swap_b32 v148, v150
  v_permlane16_swap_b32 v149, v151
  v_permlane16_swap_b32 v152, v154
  v_permlane16_swap_b32 v153, v155
  v_permlane16_swap_b32 v156, v158
  v_permlane16_swap_b32 v157, v159
  v_permlane16_swap_b32 v160, v162
  v_permlane16_swap_b32 v161, v163
  v_permlane16_swap_b32 v164, v166
  v_permlane16_swap_b32 v165, v167
  v_permlane16_swap_b32 v168, v170
  v_permlane16_swap_b32 v169, v171
  v_permlane16_swap_b32 v172, v174
  v_permlane16_swap_b32 v173, v175
  v_permlane16_swap_b32 v176, v178
  v_permlane16_swap_b32 v177, v179
  v_permlane16_swap_b32 v180, v182
  v_permlane16_swap_b32 v181, v183
  s_setpc_b64 s[8:9]
L_attn_finish:
  v_mov_b32 v32, v29
  v_mov_b32 v33, v30
  v_mov_b32 v34, v31
  v_mov_b32 v35, v32
  v_mov_b32 v36, v33
  v_mov_b32 v37, v34
  s_nop 1
  v_permlane16_swap_b32 v32, v35
  v_permlane16_swap_b32 v33, v36
  v_permlane16_swap_b32 v34, v37
  s_nop 0
  v_add_f32 v32, v32, v35
  v_add_f32 v33, v33, v36
  v_add_f32 v34, v34, v37
  v_mov_b32 v35, v32
  v_mov_b32 v36, v33
  v_mov_b32 v37, v34
  s_nop 1
  v_permlane32_swap_b32 v32, v35
  v_permlane32_swap_b32 v33, v36
  v_permlane32_swap_b32 v34, v37
  s_nop 0
  v_add_f32 v32, v32, v35
  v_add_f32 v33, v33, v36
  v_add_f32 v34, v34, v37
  v_rcp_f32 v32, v32
  v_rcp_f32 v33, v33
  v_rcp_f32 v34, v34
  s_mul_i32 s74, s4, 12288
  v_bfe_u32 v4, v1, 4, 1
  v_lshrrev_b32 v5, 5, v1
  v_lshl_add_u32 v4, v4, 1, v5
  v_lshrrev_b32 v5, 4, v1
  v_xor_b32 v4, v4, v5
  v_lshlrev_b32 v4, 4, v4
  v_xor_b32 v22, v4, v23
  v_add_u32 v22, s74, v22
  v_xor_b32 v5, 64, v22
  v_mul_f32 v40, v32, v40
  v_mul_f32 v41, v32, v41
  v_mul_f32 v42, v32, v42
  v_mul_f32 v43, v32, v43
  v_mul_f32 v52, v32, v52
  v_mul_f32 v53, v32, v53
  v_mul_f32 v54, v32, v54
  v_mul_f32 v55, v32, v55
  v_cvt_pk_bf16_f32 v136, v40, v41
  v_cvt_pk_bf16_f32 v137, v42, v43
  v_cvt_pk_bf16_f32 v138, v52, v53
  v_cvt_pk_bf16_f32 v139, v54, v55
  v_mul_f32 v64, v32, v64
  v_mul_f32 v65, v32, v65
  v_mul_f32 v66, v32, v66
  v_mul_f32 v67, v32, v67
  v_mul_f32 v76, v32, v76
  v_mul_f32 v77, v32, v77
  v_mul_f32 v78, v32, v78
  v_mul_f32 v79, v32, v79
  v_cvt_pk_bf16_f32 v148, v64, v65
  v_cvt_pk_bf16_f32 v149, v66, v67
  v_cvt_pk_bf16_f32 v150, v76, v77
  v_cvt_pk_bf16_f32 v151, v78, v79
  v_mul_f32 v88, v32, v88
  v_mul_f32 v89, v32, v89
  v_mul_f32 v90, v32, v90
  v_mul_f32 v91, v32, v91
  v_mul_f32 v100, v32, v100
  v_mul_f32 v101, v32, v101
  v_mul_f32 v102, v32, v102
  v_mul_f32 v103, v32, v103
  v_cvt_pk_bf16_f32 v160, v88, v89
  v_cvt_pk_bf16_f32 v161, v90, v91
  v_cvt_pk_bf16_f32 v162, v100, v101
  v_cvt_pk_bf16_f32 v163, v102, v103
  v_mul_f32 v112, v32, v112
  v_mul_f32 v113, v32, v113
  v_mul_f32 v114, v32, v114
  v_mul_f32 v115, v32, v115
  v_mul_f32 v124, v32, v124
  v_mul_f32 v125, v32, v125
  v_mul_f32 v126, v32, v126
  v_mul_f32 v127, v32, v127
  v_cvt_pk_bf16_f32 v172, v112, v113
  v_cvt_pk_bf16_f32 v173, v114, v115
  v_cvt_pk_bf16_f32 v174, v124, v125
  v_cvt_pk_bf16_f32 v175, v126, v127
  v_mul_f32 v44, v33, v44
  v_mul_f32 v45, v33, v45
  v_mul_f32 v46, v33, v46
  v_mul_f32 v47, v33, v47
  v_mul_f32 v56, v33, v56
  v_mul_f32 v57, v33, v57
  v_mul_f32 v58, v33, v58
  v_mul_f32 v59, v33, v59
  v_cvt_pk_bf16_f32 v140, v44, v45
  v_cvt_pk_bf16_f32 v141, v46, v47
  v_cvt_pk_bf16_f32 v142, v56, v57
  v_cvt_pk_bf16_f32 v143, v58, v59
  v_mul_f32 v68, v33, v68
  v_mul_f32 v69, v33, v69
  v_mul_f32 v70, v33, v70
  v_mul_f32 v71, v33, v71
  v_mul_f32 v80, v33, v80
  v_mul_f32 v81, v33, v81
  v_mul_f32 v82, v33, v82
  v_mul_f32 v83, v33, v83
  v_cvt_pk_bf16_f32 v152, v68, v69
  v_cvt_pk_bf16_f32 v153, v70, v71
  v_cvt_pk_bf16_f32 v154, v80, v81
  v_cvt_pk_bf16_f32 v155, v82, v83
  v_mul_f32 v92, v33, v92
  v_mul_f32 v93, v33, v93
  v_mul_f32 v94, v33, v94
  v_mul_f32 v95, v33, v95
  v_mul_f32 v104, v33, v104
  v_mul_f32 v105, v33, v105
  v_mul_f32 v106, v33, v106
  v_mul_f32 v107, v33, v107
  v_cvt_pk_bf16_f32 v164, v92, v93
  v_cvt_pk_bf16_f32 v165, v94, v95
  v_cvt_pk_bf16_f32 v166, v104, v105
  v_cvt_pk_bf16_f32 v167, v106, v107
  v_mul_f32 v116, v33, v116
  v_mul_f32 v117, v33, v117
  v_mul_f32 v118, v33, v118
  v_mul_f32 v119, v33, v119
  v_mul_f32 v128, v33, v128
  v_mul_f32 v129, v33, v129
  v_mul_f32 v130, v33, v130
  v_mul_f32 v131, v33, v131
  v_cvt_pk_bf16_f32 v176, v116, v117
  v_cvt_pk_bf16_f32 v177, v118, v119
  v_cvt_pk_bf16_f32 v178, v128, v129
  v_cvt_pk_bf16_f32 v179, v130, v131
  v_mul_f32 v48, v34, v48
  v_mul_f32 v49, v34, v49
  v_mul_f32 v50, v34, v50
  v_mul_f32 v51, v34, v51
  v_mul_f32 v60, v34, v60
  v_mul_f32 v61, v34, v61
  v_mul_f32 v62, v34, v62
  v_mul_f32 v63, v34, v63
  v_cvt_pk_bf16_f32 v144, v48, v49
  v_cvt_pk_bf16_f32 v145, v50, v51
  v_cvt_pk_bf16_f32 v146, v60, v61
  v_cvt_pk_bf16_f32 v147, v62, v63
  v_mul_f32 v72, v34, v72
  v_mul_f32 v73, v34, v73
  v_mul_f32 v74, v34, v74
  v_mul_f32 v75, v34, v75
  v_mul_f32 v84, v34, v84
  v_mul_f32 v85, v34, v85
  v_mul_f32 v86, v34, v86
  v_mul_f32 v87, v34, v87
  v_cvt_pk_bf16_f32 v156, v72, v73
  v_cvt_pk_bf16_f32 v157, v74, v75
  v_cvt_pk_bf16_f32 v158, v84, v85
  v_cvt_pk_bf16_f32 v159, v86, v87
  v_mul_f32 v96, v34, v96
  v_mul_f32 v97, v34, v97
  v_mul_f32 v98, v34, v98
  v_mul_f32 v99, v34, v99
  v_mul_f32 v108, v34, v108
  v_mul_f32 v109, v34, v109
  v_mul_f32 v110, v34, v110
  v_mul_f32 v111, v34, v111
  v_cvt_pk_bf16_f32 v168, v96, v97
  v_cvt_pk_bf16_f32 v169, v98, v99
  v_cvt_pk_bf16_f32 v170, v108, v109
  v_cvt_pk_bf16_f32 v171, v110, v111
  v_mul_f32 v120, v34, v120
  v_mul_f32 v121, v34, v121
  v_mul_f32 v122, v34, v122
  v_mul_f32 v123, v34, v123
  v_mul_f32 v132, v34, v132
  v_mul_f32 v133, v34, v133
  v_mul_f32 v134, v34, v134
  v_mul_f32 v135, v34, v135
  v_cvt_pk_bf16_f32 v180, v120, v121
  v_cvt_pk_bf16_f32 v181, v122, v123
  v_cvt_pk_bf16_f32 v182, v132, v133
  v_cvt_pk_bf16_f32 v183, v134, v135
  s_nop 1
  v_permlane16_swap_b32 v136, v138
  v_permlane16_swap_b32 v137, v139
  v_permlane16_swap_b32 v140, v142
  v_permlane16_swap_b32 v141, v143
  v_permlane16_swap_b32 v144, v146
  v_permlane16_swap_b32 v145, v147
  v_permlane16_swap_b32 v148, v150
  v_permlane16_swap_b32 v149, v151
  v_permlane16_swap_b32 v152, v154
  v_permlane16_swap_b32 v153, v155
  v_permlane16_swap_b32 v156, v158
  v_permlane16_swap_b32 v157, v159
  v_permlane16_swap_b32 v160, v162
  v_permlane16_swap_b32 v161, v163
  v_permlane16_swap_b32 v164, v166
  v_permlane16_swap_b32 v165, v167
  v_permlane16_swap_b32 v168, v170
  v_permlane16_swap_b32 v169, v171
  v_permlane16_swap_b32 v172, v174
  v_permlane16_swap_b32 v173, v175
  v_permlane16_swap_b32 v176, v178
  v_permlane16_swap_b32 v177, v179
  v_permlane16_swap_b32 v180, v182
  v_permlane16_swap_b32 v181, v183
  s_setpc_b64 s[8:9]
L_reduce:
  v_lshlrev_b32 v37, 4, v1
  s_lshl_b32 s74, s79, 5
  s_add_u32 s74, s74, s5
  s_mul_i32 s74, s74, 393216
  s_lshl_b32 s75, s80, 10
  s_add_u32 s74, s74, s75
  buffer_load_dwordx4 v[136:139], v37, s[28:31], s74 offen sc1
  s_add_u32 s74, s74, 49152
  buffer_load_dwordx4 v[140:143], v37, s[28:31], s74 offen sc1
  s_add_u32 s74, s74, 49152
  buffer_load_dwordx4 v[144:147], v37, s[28:31], s74 offen sc1
  s_add_u32 s74, s74, 49152
  buffer_load_dwordx4 v[148:151], v37, s[28:31], s74 offen sc1
  s_add_u32 s74, s74, 49152
  buffer_load_dwordx4 v[152:155], v37, s[28:31], s74 offen sc1
  s_add_u32 s74, s74, 49152
  buffer_load_dwordx4 v[156:159], v37, s[28:31], s74 offen sc1
  s_add_u32 s74, s74, 49152
  buffer_load_dwordx4 v[160:163], v37, s[28:31], s74 offen sc1
  s_add_u32 s74, s74, 49152
  buffer_load_dwordx4 v[164:167], v37, s[28:31], s74 offen sc1
  s_mul_hi_u32 s74, s80, 0x55555556
  s_mul_i32 s75, s74, 3
  s_sub_u32 s75, s80, s75
  s_lshl_b32 s74, s74, 6
  s_lshl_b32 s75, s75, 15
  s_add_u32 s74, s74, s75
  s_mul_i32 s75, s5, 98304
  s_add_u32 s74, s74, s75
  s_lshl_b32 s75, s79, 10
  s_add_u32 s74, s74, s75
  v_and_b32 v4, 15, v1
  v_lshlrev_b32 v4, 11, v4
  v_bfe_u32 v3, v1, 4, 1
  v_lshrrev_b32 v5, 5, v1
  v_lshl_add_u32 v3, v3, 1, v5
  v_lshl_add_u32 v4, v3, 4, v4
  s_waitcnt vmcnt(7)
  v_lshlrev_b32 v224, 16, v136
  v_and_b32 v225, 0xffff0000, v136
  v_lshlrev_b32 v226, 16, v137
  v_and_b32 v227, 0xffff0000, v137
  v_lshlrev_b32 v228, 16, v138
  v_and_b32 v229, 0xffff0000, v138
  v_lshlrev_b32 v230, 16, v139
  v_and_b32 v231, 0xffff0000, v139
  s_waitcnt vmcnt(6)
  v_lshlrev_b32 v2, 16, v140
  v_and_b32 v3, 0xffff0000, v140
  v_add_f32 v224, v224, v2
  v_add_f32 v225, v225, v3
  v_lshlrev_b32 v2, 16, v141
  v_and_b32 v3, 0xffff0000, v141
  v_add_f32 v226, v226, v2
  v_add_f32 v227, v227, v3
  v_lshlrev_b32 v2, 16, v142
  v_and_b32 v3, 0xffff0000, v142
  v_add_f32 v228, v228, v2
  v_add_f32 v229, v229, v3
  v_lshlrev_b32 v2, 16, v143
  v_and_b32 v3, 0xffff0000, v143
  v_add_f32 v230, v230, v2
  v_add_f32 v231, v231, v3
  s_waitcnt vmcnt(5)
  v_lshlrev_b32 v2, 16, v144
  v_and_b32 v3, 0xffff0000, v144
  v_add_f32 v224, v224, v2
  v_add_f32 v225, v225, v3
  v_lshlrev_b32 v2, 16, v145
  v_and_b32 v3, 0xffff0000, v145
  v_add_f32 v226, v226, v2
  v_add_f32 v227, v227, v3
  v_lshlrev_b32 v2, 16, v146
  v_and_b32 v3, 0xffff0000, v146
  v_add_f32 v228, v228, v2
  v_add_f32 v229, v229, v3
  v_lshlrev_b32 v2, 16, v147
  v_and_b32 v3, 0xffff0000, v147
  v_add_f32 v230, v230, v2
  v_add_f32 v231, v231, v3
  s_waitcnt vmcnt(4)
  v_lshlrev_b32 v2, 16, v148
  v_and_b32 v3, 0xffff0000, v148
  v_add_f32 v224, v224, v2
  v_add_f32 v225, v225, v3
  v_lshlrev_b32 v2, 16, v149
  v_and_b32 v3, 0xffff0000, v149
  v_add_f32 v226, v226, v2
  v_add_f32 v227, v227, v3
  v_lshlrev_b32 v2, 16, v150
  v_and_b32 v3, 0xffff0000, v150
  v_add_f32 v228, v228, v2
  v_add_f32 v229, v229, v3
  v_lshlrev_b32 v2, 16, v151
  v_and_b32 v3, 0xffff0000, v151
  v_add_f32 v230, v230, v2
  v_add_f32 v231, v231, v3
  s_waitcnt vmcnt(3)
  v_lshlrev_b32 v2, 16, v152
  v_and_b32 v3, 0xffff0000, v152
  v_add_f32 v224, v224, v2
  v_add_f32 v225, v225, v3
  v_lshlrev_b32 v2, 16, v153
  v_and_b32 v3, 0xffff0000, v153
  v_add_f32 v226, v226, v2
  v_add_f32 v227, v227, v3
  v_lshlrev_b32 v2, 16, v154
  v_and_b32 v3, 0xffff0000, v154
  v_add_f32 v228, v228, v2
  v_add_f32 v229, v229, v3
  v_lshlrev_b32 v2, 16, v155
  v_and_b32 v3, 0xffff0000, v155
  v_add_f32 v230, v230, v2
  v_add_f32 v231, v231, v3
  s_waitcnt vmcnt(2)
  v_lshlrev_b32 v2, 16, v156
  v_and_b32 v3, 0xffff0000, v156
  v_add_f32 v224, v224, v2
  v_add_f32 v225, v225, v3
  v_lshlrev_b32 v2, 16, v157
  v_and_b32 v3, 0xffff0000, v157
  v_add_f32 v226, v226, v2
  v_add_f32 v227, v227, v3
  v_lshlrev_b32 v2, 16, v158
  v_and_b32 v3, 0xffff0000, v158
  v_add_f32 v228, v228, v2
  v_add_f32 v229, v229, v3
  v_lshlrev_b32 v2, 16, v159
  v_and_b32 v3, 0xffff0000, v159
  v_add_f32 v230, v230, v2
  v_add_f32 v231, v231, v3
  s_waitcnt vmcnt(1)
  v_lshlrev_b32 v2, 16, v160
  v_and_b32 v3, 0xffff0000, v160
  v_add_f32 v224, v224, v2
  v_add_f32 v225, v225, v3
  v_lshlrev_b32 v2, 16, v161
  v_and_b32 v3, 0xffff0000, v161
  v_add_f32 v226, v226, v2
  v_add_f32 v227, v227, v3
  v_lshlrev_b32 v2, 16, v162
  v_and_b32 v3, 0xffff0000, v162
  v_add_f32 v228, v228, v2
  v_add_f32 v229, v229, v3
  v_lshlrev_b32 v2, 16, v163
  v_and_b32 v3, 0xffff0000, v163
  v_add_f32 v230, v230, v2
  v_add_f32 v231, v231, v3
  s_waitcnt vmcnt(0)
  v_lshlrev_b32 v2, 16, v164
  v_and_b32 v3, 0xffff0000, v164
  v_add_f32 v224, v224, v2
  v_add_f32 v225, v225, v3
  v_lshlrev_b32 v2, 16, v165
  v_and_b32 v3, 0xffff0000, v165
  v_add_f32 v226, v226, v2
  v_add_f32 v227, v227, v3
  v_lshlrev_b32 v2, 16, v166
  v_and_b32 v3, 0xffff0000, v166
  v_add_f32 v228, v228, v2
  v_add_f32 v229, v229, v3
  v_lshlrev_b32 v2, 16, v167
  v_and_b32 v3, 0xffff0000, v167
  v_add_f32 v230, v230, v2
  v_add_f32 v231, v231, v3
  v_cvt_pk_bf16_f32 v232, v224, v225
  v_cvt_pk_bf16_f32 v233, v226, v227
  v_cvt_pk_bf16_f32 v234, v228, v229
  v_cvt_pk_bf16_f32 v235, v230, v231
  buffer_store_dwordx4 v[232:235], v4, s[32:35], s74 offen
  s_waitcnt vmcnt(0)
  s_setpc_b64 s[8:9]
L_code_end:
  s_endpgm
.section .rodata,"a"
.p2align 6
.amdhsa_kernel concat_heads__gqa_block_cached__mha_block_cached__near_ridge_kernel
  .amdhsa_next_free_vgpr 256
  .amdhsa_next_free_sgpr 102
  .amdhsa_accum_offset 256
  .amdhsa_group_segment_fixed_size 0
  .amdhsa_kernarg_size 104
  .amdhsa_user_sgpr_count 2
  .amdhsa_user_sgpr_kernarg_segment_ptr 1
  .amdhsa_system_sgpr_workgroup_id_x 1
.end_amdhsa_kernel
```
